```python
import torch

def _softmax(x, axis=-1):
    return torch.softmax(x, dim=axis)
def _gelu(x):
    return torch.nn.functional.gelu(x, approximate="tanh")
def _silu(x):
    return torch.nn.functional.silu(x)
def _sigmoid(x):
    return torch.sigmoid(x)
def _layernorm(x, axis=-1, eps=1e-5):
    m = x.mean(dim=axis, keepdim=True)
    v = x.var(dim=axis, keepdim=True, unbiased=False)
    return (x - m) / torch.sqrt(v + eps)
def _scatter_add(tgt, idx, src, axis=0):
    return tgt.clone().index_add_(axis, idx, src)
def _segment_sum(src, seg, n):
    out = torch.zeros((n,) + src.shape[1:], dtype=src.dtype)
    return out.index_add_(0, seg, src)
def _pad(x, pw):
    flat = tuple(v for pair in reversed(pw) for v in pair)
    return torch.nn.functional.pad(x, flat)

kernel_name = 'gated_mix__softmax_full_mha__softmax_full_mha__prompt'

def setup_inputs():

    _w = (lambda a: (lambda t: t.to(torch.bfloat16) if t.is_floating_point() else t)(torch.as_tensor(a)))
    def _A_setup():
        B, S, D = 1, 2048, 576
        return {
            "x": _w((lambda *s: torch.randn(*s, dtype=torch.bfloat16) * 0.05)(B, S, D)),
            "wqkv": _w((lambda *s: torch.randn(*s, dtype=torch.bfloat16) * 0.8)(D, 3 * D)),
            "wo": _w((lambda *s: torch.randn(*s, dtype=torch.bfloat16) * 0.05)(D, D)),
        }
    _A_in = _A_setup()

    def _B_setup():
        B, S, D = 1, 2048, 576
        return {
            "x": _w((lambda *s: torch.randn(*s, dtype=torch.bfloat16) * 0.05)(B, S, D)),
            "wqkv": _w((lambda *s: torch.randn(*s, dtype=torch.bfloat16) * 0.8)(D, 3 * D)),
            "wo": _w((lambda *s: torch.randn(*s, dtype=torch.bfloat16) * 0.05)(D, D)),
        }
    _B_in = _B_setup()

    return {
        "A_x": _A_in["x"],
        "A_wqkv": _A_in["wqkv"],
        "A_wo": _A_in["wo"],
        "B_x": _B_in["x"],
        "B_wqkv": _B_in["wqkv"],
        "B_wo": _B_in["wo"],
        "gate_w": _w((lambda *s: torch.randn(*s, dtype=torch.bfloat16) * 0.05)(576) * 16.0),
    }

def reference(A_x, A_wqkv, A_wo, B_x, B_wqkv, B_wo, gate_w):
    def _A_ref(x, wqkv, wo):
        B, S, D = x.shape
        H = 32; Dh = D // H
        qkv = (lambda x, *d: x.permute(*d))((x @ wqkv).reshape(B, S, 3, H, Dh), 2, 0, 3, 1, 4)
        q, k, v = qkv[0], qkv[1], qkv[2]
        scale = Dh ** -0.5
        scores = torch.einsum("bhqd,bhkd->bhqk", q, k) * scale
        p = _softmax(scores, axis=-1)
        o = torch.einsum("bhqk,bhkd->bhqd", p, v)
        return (lambda x, *d: x.permute(*d))(o, 0, 2, 1, 3).reshape(B, S, D) @ wo

    def _B_ref(x, wqkv, wo):
        B, S, D = x.shape
        H = 32; Dh = D // H
        qkv = (lambda x, *d: x.permute(*d))((x @ wqkv).reshape(B, S, 3, H, Dh), 2, 0, 3, 1, 4)
        q, k, v = qkv[0], qkv[1], qkv[2]
        scale = Dh ** -0.5
        scores = torch.einsum("bhqd,bhkd->bhqk", q, k) * scale
        p = _softmax(scores, axis=-1)
        o = torch.einsum("bhqk,bhkd->bhqd", p, v)
        return (lambda x, *d: x.permute(*d))(o, 0, 2, 1, 3).reshape(B, S, D) @ wo

    x = A_x
    g = _sigmoid((x * gate_w).sum(-1, keepdims=True))
    a = _A_ref(x, A_wqkv, A_wo)
    b = _B_ref(x, B_wqkv, B_wo)
    return g * a + (1 - g) * b
```

```asm
; @launch grid=(256,1,1) block=(512,1,1) lds=160512
.amdgcn_target "amdgcn-amd-amdhsa--gfx950"
.text
.globl gated_mix__softmax_full_mha__softmax_full_mha__prompt_kernel
.p2align 8
.type gated_mix__softmax_full_mha__softmax_full_mha__prompt_kernel,@function
gated_mix__softmax_full_mha__softmax_full_mha__prompt_kernel:
    s_cmp_ge_u32 s2, 256
    s_cbranch_scc1 .Lend
    s_load_dwordx16 s[28:43], s[0:1], 0
    s_load_dwordx4 s[44:47], s[0:1], 64
    v_lshrrev_b32 v1, 6, v0
    v_and_b32 v252, 63, v0
    v_readfirstlane_b32 s3, v1
    s_and_b32 s4, s2, 7
    s_lshr_b32 s5, s2, 3
    s_getreg_b32 s6, hwreg(HW_REG_XCC_ID, 0, 4)
    s_add_u32 s6, s6, 1
    s_lshr_b32 s48, s5, 1
    s_and_b32 s49, s5, 1
    s_cmp_ge_u32 s3, 4
    s_cbranch_scc0 .Lconsumer
    s_sub_u32 s50, s3, 4
    v_lshrrev_b32 v1, 3, v252
    v_and_b32 v2, 7, v252
    v_lshrrev_b32 v3, 4, v252
    v_xor_b32 v4, v2, v3
    v_xor_b32 v5, 4, v4
    s_lshl_b32 s51, s48, 7
    s_lshl_b32 s52, s50, 5
    s_add_u32 s51, s51, s52
    v_add_u32 v1, s51, v1
    v_mul_u32_u24 v1, 1152, v1
    v_lshl_add_u32 v10, v4, 4, v1
    v_lshl_add_u32 v11, v5, 4, v1
    v_add_u32 v11, 9216, v11
    v_lshl_add_u32 v12, v4, 4, v1
    v_add_u32 v12, 18432, v12
    v_lshl_add_u32 v13, v5, 4, v1
    v_add_u32 v13, 27648, v13
    s_lshl_b32 s56, s50, 12
    s_add_u32 s56, s56, 98304
    s_lshl_b32 s57, s50, 10
    s_and_b32 s52, s4, 3
    s_mul_i32 s52, s52, 288
    s_and_b32 s53, s52, 0xffc0
    s_add_u32 s54, s52, 144
    s_and_b32 s54, s54, 0xffc0
    s_add_u32 s54, s54, 1152
    s_mov_b32 s55, 2112
    s_cmp_eq_u32 s49, 0
    s_cselect_b32 s54, s53, s54
    s_cselect_b32 s55, 832, s55
    s_cselect_b32 s58, 20, 12
    s_add_u32 s55, s55, s53
    v_lshrrev_b32 v1, 5, v252
    v_lshlrev_b32 v2, 1, v1
    v_xor_b32 v2, v252, v2
    s_and_b32 s59, s50, 1
    s_lshl_b32 s59, s59, 2
    v_subrev_u32 v2, s59, v2
    s_lshl_b32 s59, s50, 1
    v_add_u32 v1, s59, v1
    v_mul_u32_u24 v1, 3456, v1
    v_mov_b32 v5, s54
    v_mov_b32 v6, s55
    v_and_b32 v3, 31, v2
    v_cmp_gt_u32 vcc, s58, v3
    v_lshl_add_u32 v3, v3, 4, v1
    s_nop 0
    v_cndmask_b32 v4, v6, v5, vcc
    v_add_u32 v14, v3, v4
    v_subrev_u32 v2, 8, v2
    v_and_b32 v3, 31, v2
    v_cmp_gt_u32 vcc, s58, v3
    v_lshl_add_u32 v3, v3, 4, v1
    s_nop 0
    v_cndmask_b32 v4, v6, v5, vcc
    v_add_u32 v15, v3, v4
    s_waitcnt lgkmcnt(0)
    s_mov_b32 s8, s46
    s_mov_b32 s9, s47
    s_mov_b32 s10, 268435456
    s_mov_b32 s11, 0x00020000
    s_mov_b32 s12, s28
    s_mov_b32 s13, s29
    s_mov_b32 s14, 2359296
    s_mov_b32 s15, 0x00020000
    s_cmp_lt_u32 s4, 4
    s_cselect_b32 s16, s30, s36
    s_cselect_b32 s17, s31, s37
    s_mov_b32 s18, 1990656
    s_mov_b32 s19, 0x00020000
    s_mov_b32 s60, 0
    s_add_u32 m0, s56, 0
    s_nop 0
    buffer_load_dwordx4 v10, s[12:15], s60 offen lds
    s_add_u32 m0, s56, 1024
    s_nop 0
    buffer_load_dwordx4 v11, s[12:15], s60 offen lds
    s_add_u32 m0, s56, 2048
    s_nop 0
    buffer_load_dwordx4 v12, s[12:15], s60 offen lds
    s_add_u32 m0, s56, 3072
    s_nop 0
    buffer_load_dwordx4 v13, s[12:15], s60 offen lds
    s_add_u32 m0, s57, 0
    s_mov_b32 s61, 0
    buffer_load_dwordx4 v14, s[16:19], s61 offen lds
    s_add_u32 m0, s57, 4096
    s_mov_b32 s61, 27648
    buffer_load_dwordx4 v15, s[16:19], s61 offen lds
    s_add_u32 m0, s57, 8192
    s_mov_b32 s61, 55296
    buffer_load_dwordx4 v14, s[16:19], s61 offen lds
    s_add_u32 m0, s57, 12288
    s_mov_b32 s61, 82944
    buffer_load_dwordx4 v15, s[16:19], s61 offen lds
    s_add_u32 m0, s57, 16384
    s_mov_b32 s61, 110592
    buffer_load_dwordx4 v14, s[16:19], s61 offen lds
    s_add_u32 m0, s57, 20480
    s_mov_b32 s61, 138240
    buffer_load_dwordx4 v15, s[16:19], s61 offen lds
    s_add_u32 m0, s57, 24576
    s_mov_b32 s61, 165888
    buffer_load_dwordx4 v14, s[16:19], s61 offen lds
    s_add_u32 m0, s57, 28672
    s_mov_b32 s61, 193536
    buffer_load_dwordx4 v15, s[16:19], s61 offen lds
    s_mov_b32 s60, 128
    s_add_u32 m0, s56, 16384
    s_nop 0
    buffer_load_dwordx4 v10, s[12:15], s60 offen lds
    s_add_u32 m0, s56, 17408
    s_nop 0
    buffer_load_dwordx4 v11, s[12:15], s60 offen lds
    s_add_u32 m0, s56, 18432
    s_nop 0
    buffer_load_dwordx4 v12, s[12:15], s60 offen lds
    s_add_u32 m0, s56, 19456
    s_nop 0
    buffer_load_dwordx4 v13, s[12:15], s60 offen lds
    s_add_u32 m0, s57, 32768
    s_mov_b32 s61, 221184
    buffer_load_dwordx4 v14, s[16:19], s61 offen lds
    s_add_u32 m0, s57, 36864
    s_mov_b32 s61, 248832
    buffer_load_dwordx4 v15, s[16:19], s61 offen lds
    s_add_u32 m0, s57, 40960
    s_mov_b32 s61, 276480
    buffer_load_dwordx4 v14, s[16:19], s61 offen lds
    s_add_u32 m0, s57, 45056
    s_mov_b32 s61, 304128
    buffer_load_dwordx4 v15, s[16:19], s61 offen lds
    s_add_u32 m0, s57, 49152
    s_mov_b32 s61, 331776
    buffer_load_dwordx4 v14, s[16:19], s61 offen lds
    s_add_u32 m0, s57, 53248
    s_mov_b32 s61, 359424
    buffer_load_dwordx4 v15, s[16:19], s61 offen lds
    s_add_u32 m0, s57, 57344
    s_mov_b32 s61, 387072
    buffer_load_dwordx4 v14, s[16:19], s61 offen lds
    s_add_u32 m0, s57, 61440
    s_mov_b32 s61, 414720
    buffer_load_dwordx4 v15, s[16:19], s61 offen lds
    s_waitcnt vmcnt(12)
    s_barrier
    s_mov_b32 s60, 256
    s_add_u32 m0, s56, 32768
    s_nop 0
    buffer_load_dwordx4 v10, s[12:15], s60 offen lds
    s_add_u32 m0, s56, 33792
    s_nop 0
    buffer_load_dwordx4 v11, s[12:15], s60 offen lds
    s_add_u32 m0, s56, 34816
    s_nop 0
    buffer_load_dwordx4 v12, s[12:15], s60 offen lds
    s_add_u32 m0, s56, 35840
    s_nop 0
    buffer_load_dwordx4 v13, s[12:15], s60 offen lds
    s_add_u32 m0, s57, 65536
    s_mov_b32 s61, 442368
    buffer_load_dwordx4 v14, s[16:19], s61 offen lds
    s_add_u32 m0, s57, 69632
    s_mov_b32 s61, 470016
    buffer_load_dwordx4 v15, s[16:19], s61 offen lds
    s_add_u32 m0, s57, 73728
    s_mov_b32 s61, 497664
    buffer_load_dwordx4 v14, s[16:19], s61 offen lds
    s_add_u32 m0, s57, 77824
    s_mov_b32 s61, 525312
    buffer_load_dwordx4 v15, s[16:19], s61 offen lds
    s_add_u32 m0, s57, 81920
    s_mov_b32 s61, 552960
    buffer_load_dwordx4 v14, s[16:19], s61 offen lds
    s_add_u32 m0, s57, 86016
    s_mov_b32 s61, 580608
    buffer_load_dwordx4 v15, s[16:19], s61 offen lds
    s_add_u32 m0, s57, 90112
    s_mov_b32 s61, 608256
    buffer_load_dwordx4 v14, s[16:19], s61 offen lds
    s_add_u32 m0, s57, 94208
    s_mov_b32 s61, 635904
    buffer_load_dwordx4 v15, s[16:19], s61 offen lds
    s_waitcnt vmcnt(12)
    s_barrier
    s_mov_b32 s60, 384
    s_add_u32 m0, s56, 0
    s_nop 0
    buffer_load_dwordx4 v10, s[12:15], s60 offen lds
    s_add_u32 m0, s56, 1024
    s_nop 0
    buffer_load_dwordx4 v11, s[12:15], s60 offen lds
    s_add_u32 m0, s56, 2048
    s_nop 0
    buffer_load_dwordx4 v12, s[12:15], s60 offen lds
    s_add_u32 m0, s56, 3072
    s_nop 0
    buffer_load_dwordx4 v13, s[12:15], s60 offen lds
    s_add_u32 m0, s57, 0
    s_mov_b32 s61, 663552
    buffer_load_dwordx4 v14, s[16:19], s61 offen lds
    s_add_u32 m0, s57, 4096
    s_mov_b32 s61, 691200
    buffer_load_dwordx4 v15, s[16:19], s61 offen lds
    s_add_u32 m0, s57, 8192
    s_mov_b32 s61, 718848
    buffer_load_dwordx4 v14, s[16:19], s61 offen lds
    s_add_u32 m0, s57, 12288
    s_mov_b32 s61, 746496
    buffer_load_dwordx4 v15, s[16:19], s61 offen lds
    s_add_u32 m0, s57, 16384
    s_mov_b32 s61, 774144
    buffer_load_dwordx4 v14, s[16:19], s61 offen lds
    s_add_u32 m0, s57, 20480
    s_mov_b32 s61, 801792
    buffer_load_dwordx4 v15, s[16:19], s61 offen lds
    s_add_u32 m0, s57, 24576
    s_mov_b32 s61, 829440
    buffer_load_dwordx4 v14, s[16:19], s61 offen lds
    s_add_u32 m0, s57, 28672
    s_mov_b32 s61, 857088
    buffer_load_dwordx4 v15, s[16:19], s61 offen lds
    s_waitcnt vmcnt(12)
    s_barrier
    s_mov_b32 s60, 512
    s_add_u32 m0, s56, 16384
    s_nop 0
    buffer_load_dwordx4 v10, s[12:15], s60 offen lds
    s_add_u32 m0, s56, 17408
    s_nop 0
    buffer_load_dwordx4 v11, s[12:15], s60 offen lds
    s_add_u32 m0, s56, 18432
    s_nop 0
    buffer_load_dwordx4 v12, s[12:15], s60 offen lds
    s_add_u32 m0, s56, 19456
    s_nop 0
    buffer_load_dwordx4 v13, s[12:15], s60 offen lds
    s_add_u32 m0, s57, 32768
    s_mov_b32 s61, 884736
    buffer_load_dwordx4 v14, s[16:19], s61 offen lds
    s_add_u32 m0, s57, 36864
    s_mov_b32 s61, 912384
    buffer_load_dwordx4 v15, s[16:19], s61 offen lds
    s_add_u32 m0, s57, 40960
    s_mov_b32 s61, 940032
    buffer_load_dwordx4 v14, s[16:19], s61 offen lds
    s_add_u32 m0, s57, 45056
    s_mov_b32 s61, 967680
    buffer_load_dwordx4 v15, s[16:19], s61 offen lds
    s_add_u32 m0, s57, 49152
    s_mov_b32 s61, 995328
    buffer_load_dwordx4 v14, s[16:19], s61 offen lds
    s_add_u32 m0, s57, 53248
    s_mov_b32 s61, 1022976
    buffer_load_dwordx4 v15, s[16:19], s61 offen lds
    s_add_u32 m0, s57, 57344
    s_mov_b32 s61, 1050624
    buffer_load_dwordx4 v14, s[16:19], s61 offen lds
    s_add_u32 m0, s57, 61440
    s_mov_b32 s61, 1078272
    buffer_load_dwordx4 v15, s[16:19], s61 offen lds
    s_waitcnt vmcnt(12)
    s_barrier
    s_mov_b32 s60, 640
    s_add_u32 m0, s56, 32768
    s_nop 0
    buffer_load_dwordx4 v10, s[12:15], s60 offen lds
    s_add_u32 m0, s56, 33792
    s_nop 0
    buffer_load_dwordx4 v11, s[12:15], s60 offen lds
    s_add_u32 m0, s56, 34816
    s_nop 0
    buffer_load_dwordx4 v12, s[12:15], s60 offen lds
    s_add_u32 m0, s56, 35840
    s_nop 0
    buffer_load_dwordx4 v13, s[12:15], s60 offen lds
    s_add_u32 m0, s57, 65536
    s_mov_b32 s61, 1105920
    buffer_load_dwordx4 v14, s[16:19], s61 offen lds
    s_add_u32 m0, s57, 69632
    s_mov_b32 s61, 1133568
    buffer_load_dwordx4 v15, s[16:19], s61 offen lds
    s_add_u32 m0, s57, 73728
    s_mov_b32 s61, 1161216
    buffer_load_dwordx4 v14, s[16:19], s61 offen lds
    s_add_u32 m0, s57, 77824
    s_mov_b32 s61, 1188864
    buffer_load_dwordx4 v15, s[16:19], s61 offen lds
    s_add_u32 m0, s57, 81920
    s_mov_b32 s61, 1216512
    buffer_load_dwordx4 v14, s[16:19], s61 offen lds
    s_add_u32 m0, s57, 86016
    s_mov_b32 s61, 1244160
    buffer_load_dwordx4 v15, s[16:19], s61 offen lds
    s_add_u32 m0, s57, 90112
    s_mov_b32 s61, 1271808
    buffer_load_dwordx4 v14, s[16:19], s61 offen lds
    s_add_u32 m0, s57, 94208
    s_mov_b32 s61, 1299456
    buffer_load_dwordx4 v15, s[16:19], s61 offen lds
    s_waitcnt vmcnt(12)
    s_barrier
    s_mov_b32 s60, 768
    s_add_u32 m0, s56, 0
    s_nop 0
    buffer_load_dwordx4 v10, s[12:15], s60 offen lds
    s_add_u32 m0, s56, 1024
    s_nop 0
    buffer_load_dwordx4 v11, s[12:15], s60 offen lds
    s_add_u32 m0, s56, 2048
    s_nop 0
    buffer_load_dwordx4 v12, s[12:15], s60 offen lds
    s_add_u32 m0, s56, 3072
    s_nop 0
    buffer_load_dwordx4 v13, s[12:15], s60 offen lds
    s_add_u32 m0, s57, 0
    s_mov_b32 s61, 1327104
    buffer_load_dwordx4 v14, s[16:19], s61 offen lds
    s_add_u32 m0, s57, 4096
    s_mov_b32 s61, 1354752
    buffer_load_dwordx4 v15, s[16:19], s61 offen lds
    s_add_u32 m0, s57, 8192
    s_mov_b32 s61, 1382400
    buffer_load_dwordx4 v14, s[16:19], s61 offen lds
    s_add_u32 m0, s57, 12288
    s_mov_b32 s61, 1410048
    buffer_load_dwordx4 v15, s[16:19], s61 offen lds
    s_add_u32 m0, s57, 16384
    s_mov_b32 s61, 1437696
    buffer_load_dwordx4 v14, s[16:19], s61 offen lds
    s_add_u32 m0, s57, 20480
    s_mov_b32 s61, 1465344
    buffer_load_dwordx4 v15, s[16:19], s61 offen lds
    s_add_u32 m0, s57, 24576
    s_mov_b32 s61, 1492992
    buffer_load_dwordx4 v14, s[16:19], s61 offen lds
    s_add_u32 m0, s57, 28672
    s_mov_b32 s61, 1520640
    buffer_load_dwordx4 v15, s[16:19], s61 offen lds
    s_waitcnt vmcnt(12)
    s_barrier
    s_mov_b32 s60, 896
    s_add_u32 m0, s56, 16384
    s_nop 0
    buffer_load_dwordx4 v10, s[12:15], s60 offen lds
    s_add_u32 m0, s56, 17408
    s_nop 0
    buffer_load_dwordx4 v11, s[12:15], s60 offen lds
    s_add_u32 m0, s56, 18432
    s_nop 0
    buffer_load_dwordx4 v12, s[12:15], s60 offen lds
    s_add_u32 m0, s56, 19456
    s_nop 0
    buffer_load_dwordx4 v13, s[12:15], s60 offen lds
    s_add_u32 m0, s57, 32768
    s_mov_b32 s61, 1548288
    buffer_load_dwordx4 v14, s[16:19], s61 offen lds
    s_add_u32 m0, s57, 36864
    s_mov_b32 s61, 1575936
    buffer_load_dwordx4 v15, s[16:19], s61 offen lds
    s_add_u32 m0, s57, 40960
    s_mov_b32 s61, 1603584
    buffer_load_dwordx4 v14, s[16:19], s61 offen lds
    s_add_u32 m0, s57, 45056
    s_mov_b32 s61, 1631232
    buffer_load_dwordx4 v15, s[16:19], s61 offen lds
    s_add_u32 m0, s57, 49152
    s_mov_b32 s61, 1658880
    buffer_load_dwordx4 v14, s[16:19], s61 offen lds
    s_add_u32 m0, s57, 53248
    s_mov_b32 s61, 1686528
    buffer_load_dwordx4 v15, s[16:19], s61 offen lds
    s_add_u32 m0, s57, 57344
    s_mov_b32 s61, 1714176
    buffer_load_dwordx4 v14, s[16:19], s61 offen lds
    s_add_u32 m0, s57, 61440
    s_mov_b32 s61, 1741824
    buffer_load_dwordx4 v15, s[16:19], s61 offen lds
    s_waitcnt vmcnt(12)
    s_barrier
    s_mov_b32 s60, 1024
    s_add_u32 m0, s56, 32768
    s_nop 0
    buffer_load_dwordx4 v10, s[12:15], s60 offen lds
    s_add_u32 m0, s56, 33792
    s_nop 0
    buffer_load_dwordx4 v11, s[12:15], s60 offen lds
    s_add_u32 m0, s56, 34816
    s_nop 0
    buffer_load_dwordx4 v12, s[12:15], s60 offen lds
    s_add_u32 m0, s56, 35840
    s_nop 0
    buffer_load_dwordx4 v13, s[12:15], s60 offen lds
    s_add_u32 m0, s57, 65536
    s_mov_b32 s61, 1769472
    buffer_load_dwordx4 v14, s[16:19], s61 offen lds
    s_add_u32 m0, s57, 69632
    s_mov_b32 s61, 1797120
    buffer_load_dwordx4 v15, s[16:19], s61 offen lds
    s_add_u32 m0, s57, 73728
    s_mov_b32 s61, 1824768
    buffer_load_dwordx4 v14, s[16:19], s61 offen lds
    s_add_u32 m0, s57, 77824
    s_mov_b32 s61, 1852416
    buffer_load_dwordx4 v15, s[16:19], s61 offen lds
    s_add_u32 m0, s57, 81920
    s_mov_b32 s61, 1880064
    buffer_load_dwordx4 v14, s[16:19], s61 offen lds
    s_add_u32 m0, s57, 86016
    s_mov_b32 s61, 1907712
    buffer_load_dwordx4 v15, s[16:19], s61 offen lds
    s_add_u32 m0, s57, 90112
    s_mov_b32 s61, 1935360
    buffer_load_dwordx4 v14, s[16:19], s61 offen lds
    s_add_u32 m0, s57, 94208
    s_mov_b32 s61, 1963008
    buffer_load_dwordx4 v15, s[16:19], s61 offen lds
    s_waitcnt vmcnt(12)
    s_barrier
    s_mov_b32 s24, s44
    s_mov_b32 s25, s45
    s_mov_b32 s26, 256
    s_mov_b32 s27, 0x00020000
    v_lshlrev_b32 v57, 6, v252
    buffer_load_dword v58, v57, s[24:27], 0 offen sc1
    s_lshl_b32 s58, s4, 3
    s_lshr_b32 s59, s5, 2
    s_add_u32 s58, s58, s59
    s_mul_i32 s58, s58, 229376
    s_and_b32 s59, s5, 3
    s_lshl_b32 s59, s59, 2
    s_add_u32 s59, s59, s50
    s_mul_i32 s60, s59, 4608
    s_add_u32 s60, s60, 155648
    s_mul_i32 s59, s59, 2560
    s_sub_u32 s59, s59, 4608
    v_mov_b32 v1, s59
    v_mov_b32 v2, s60
    v_cmp_gt_u32 vcc, 36, v252
    v_mov_b32 v3, 0x80000000
    s_nop 0
    v_cndmask_b32 v1, v1, v2, vcc
    v_lshl_add_u32 v1, v252, 7, v1
    v_cmp_gt_u32 vcc, 56, v252
    s_nop 1
    v_cndmask_b32 v1, v3, v1, vcc
    buffer_load_dword v23, v1, s[8:11], s58 offen sc1
    s_waitcnt vmcnt(6)
    s_barrier
    s_waitcnt vmcnt(2)
    s_barrier
    s_waitcnt vmcnt(1)
    s_mov_b32 s20, s40
    s_mov_b32 s21, s41
    s_mov_b32 s22, 1152
    s_mov_b32 s23, 0x00020000
    s_lshl_b32 s52, s4, 8
    s_lshl_b32 s53, s5, 3
    s_add_u32 s52, s52, s53
    s_lshl_b32 s53, s50, 1
    s_add_u32 s52, s52, s53
    v_lshrrev_b32 v1, 5, v252
    v_add_u32 v1, s52, v1
    v_and_b32 v4, 31, v252
    v_mul_u32_u24 v2, 36, v4
    v_mov_b32 v3, 1152
    v_mad_u32_u24 v3, v1, v3, v2
    buffer_load_dwordx4 v[152:155], v3, s[12:15], 0 offen
    buffer_load_dwordx4 v[156:159], v3, s[12:15], 0 offen offset:16
    buffer_load_dword v160, v3, s[12:15], 0 offen offset:32
    buffer_load_dwordx4 v[164:167], v2, s[20:23], 0 offen
    buffer_load_dwordx4 v[168:171], v2, s[20:23], 0 offen offset:16
    buffer_load_dword v172, v2, s[20:23], 0 offen offset:32
    v_lshlrev_b32 v1, 2, v1
    v_cmp_eq_u32 vcc, 0, v4
    v_mov_b32 v5, 0x80000000
    v_mov_b32 v161, 0
    v_cndmask_b32 v174, v5, v1, vcc
    s_cmp_eq_u32 s3, 4
    s_cbranch_scc1 .Lwave4
    v_and_b32 v1, 15, v252
    v_lshrrev_b32 v2, 4, v252
    v_lshrrev_b32 v3, 2, v1
    v_and_b32 v4, 3, v1
    v_lshl_add_u32 v3, v3, 3, v4
    v_lshrrev_b32 v6, 1, v2
    v_mul_u32_u24 v6, 20, v6
    v_and_b32 v4, 1, v2
    v_lshl_add_u32 v6, v4, 3, v6
    v_mul_u32_u24 v7, 144, v2
    s_lshr_b32 s58, s2, 5
    s_mul_i32 s58, s58, 72
    s_bfe_u32 s59, s2, 0x20002
    s_mul_i32 s59, s59, 36
    s_and_b32 s62, s2, 3
    s_mul_i32 s63, s62, 144
    s_add_u32 s63, s63, s59
    s_add_u32 s59, s59, 16
    s_mov_b64 s[64:65], 0
    s_mov_b32 s66, 16
    s_lshr_b32 s60, s50, 1
    s_lshl_b32 s60, s60, 5
    s_and_b32 s61, s50, 1
    s_lshl_b32 s61, s61, 2
    s_add_u32 s60, s60, s61
    s_add_u32 s60, s60, s58
    s_cmp_eq_u32 s50, 4
    s_cselect_b64 vcc, -1, 0
    s_cselect_b32 s61, 8, 16
    s_min_u32 s61, s61, s66
    v_cndmask_b32 v4, v3, v1, vcc
    v_add_u32 v4, s60, v4
    v_cndmask_b32 v5, v6, v7, s[64:65]
    v_add_u32 v5, s63, v5
    v_mul_u32_u24 v5, 1152, v5
    v_lshl_add_u32 v5, v4, 1, v5
    v_cmp_gt_u32 vcc, s61, v1
    v_mov_b32 v4, 0x80000000
    s_nop 0
    v_cndmask_b32 v24, v4, v5, vcc
    s_cmp_eq_u32 s50, 1
    s_cselect_b32 s67, s62, 4
    s_cmp_eq_u32 s62, 0
    s_cselect_b32 s66, 3, 2
    s_cmp_lt_u32 s50, s66
    s_cselect_b32 s66, 16, 0
    s_cmp_ge_u32 s50, 1
    s_cselect_b64 s[64:65], -1, 0
    s_cselect_b32 s71, s59, s63
    s_lshr_b32 s60, s67, 1
    s_lshl_b32 s60, s60, 5
    s_and_b32 s61, s67, 1
    s_lshl_b32 s61, s61, 2
    s_add_u32 s60, s60, s61
    s_add_u32 s60, s60, s58
    s_cmp_eq_u32 s67, 4
    s_cselect_b64 vcc, -1, 0
    s_cselect_b32 s61, 8, 16
    s_min_u32 s61, s61, s66
    v_cndmask_b32 v4, v3, v1, vcc
    v_add_u32 v4, s60, v4
    v_cndmask_b32 v5, v6, v7, s[64:65]
    v_add_u32 v5, s71, v5
    v_mul_u32_u24 v5, 1152, v5
    v_lshl_add_u32 v5, v4, 1, v5
    v_cmp_gt_u32 vcc, s61, v1
    v_mov_b32 v4, 0x80000000
    s_nop 0
    v_cndmask_b32 v25, v4, v5, vcc
    s_bitcmp1_b32 s2, 4
    s_cselect_b32 s20, s38, s32
    s_cselect_b32 s21, s39, s33
    s_mov_b32 s22, 663552
    s_mov_b32 s23, 0x00020000
    s_mov_b32 s60, 4608
    buffer_load_ushort v220, v24, s[20:23], 0 offen offset:0
    buffer_load_ushort v221, v24, s[20:23], 0 offen offset:1152
    buffer_load_ushort v222, v24, s[20:23], 0 offen offset:2304
    buffer_load_ushort v223, v24, s[20:23], 0 offen offset:3456
    buffer_load_ushort v224, v24, s[20:23], s60 offen offset:0
    buffer_load_ushort v225, v24, s[20:23], s60 offen offset:1152
    buffer_load_ushort v226, v24, s[20:23], s60 offen offset:2304
    buffer_load_ushort v227, v24, s[20:23], s60 offen offset:3456
    buffer_load_ushort v228, v25, s[20:23], 0 offen offset:0
    buffer_load_ushort v229, v25, s[20:23], 0 offen offset:1152
    buffer_load_ushort v230, v25, s[20:23], 0 offen offset:2304
    buffer_load_ushort v231, v25, s[20:23], 0 offen offset:3456
    buffer_load_ushort v232, v25, s[20:23], s60 offen offset:0
    buffer_load_ushort v233, v25, s[20:23], s60 offen offset:1152
    buffer_load_ushort v234, v25, s[20:23], s60 offen offset:2304
    buffer_load_ushort v235, v25, s[20:23], s60 offen offset:3456
    s_waitcnt vmcnt(0)
    v_dot2c_f32_bf16 v161, v152, v164
    v_dot2c_f32_bf16 v161, v153, v165
    v_dot2c_f32_bf16 v161, v154, v166
    v_dot2c_f32_bf16 v161, v155, v167
    v_dot2c_f32_bf16 v161, v156, v168
    v_dot2c_f32_bf16 v161, v157, v169
    v_dot2c_f32_bf16 v161, v158, v170
    v_dot2c_f32_bf16 v161, v159, v171
    v_dot2c_f32_bf16 v161, v160, v172
    s_nop 2
    v_add_f32_dpp v161, v161, v161 quad_perm:[1,0,3,2] row_mask:0xf bank_mask:0xf
    s_nop 1
    v_add_f32_dpp v161, v161, v161 quad_perm:[2,3,0,1] row_mask:0xf bank_mask:0xf
    s_nop 1
    v_add_f32_dpp v161, v161, v161 row_half_mirror row_mask:0xf bank_mask:0xf
    s_nop 1
    v_add_f32_dpp v161, v161, v161 row_mirror row_mask:0xf bank_mask:0xf
    s_nop 1
    v_mov_b32 v162, v161
    s_nop 1
    v_permlane16_swap_b32 v161, v162
    s_nop 1
    v_add_f32 v161, v161, v162
    v_mul_f32 v161, 0xbfb8aa3b, v161
    v_exp_f32 v161, v161
    s_nop 0
    v_add_f32 v161, 1.0, v161
    v_rcp_f32 v161, v161
    s_nop 0
    v_sub_f32 v162, 1.0, v161
    v_lshl_or_b32 v220, v221, 16, v220
    v_lshl_or_b32 v221, v223, 16, v222
    v_lshl_or_b32 v222, v225, 16, v224
    v_lshl_or_b32 v223, v227, 16, v226
    v_lshl_or_b32 v228, v229, 16, v228
    v_lshl_or_b32 v229, v231, 16, v230
    v_lshl_or_b32 v230, v233, 16, v232
    v_lshl_or_b32 v231, v235, 16, v234
    s_lshl_b32 s48, s4, 3
    s_lshr_b32 s49, s5, 2
    s_add_u32 s48, s48, s49
    s_and_b32 s49, s5, 3
    s_lshl_b32 s49, s49, 3
    s_add_u32 s49, s49, s3
    s_mul_i32 s50, s48, 229376
    s_mul_i32 s51, s49, 2304
    s_add_u32 s51, s51, s50
    s_add_u32 s51, s51, 155648
    s_lshl_b32 s52, s3, 10
    s_add_u32 s53, s50, s52
    s_mov_b32 m0, s52
    v_and_b32 v2, 15, v252
    v_lshrrev_b32 v3, 4, v252
    v_lshrrev_b32 v4, 1, v3
    v_lshlrev_b32 v4, 8, v4
    v_lshrrev_b32 v5, 2, v2
    v_lshl_add_u32 v4, v5, 5, v4
    v_and_b32 v6, 1, v2
    v_bfe_u32 v7, v2, 1, 1
    v_lshl_add_u32 v6, v6, 1, v7
    v_lshlrev_b32 v6, 3, v6
    v_add_u32 v6, 2816, v6
    v_and_b32 v9, 3, v2
    v_cmp_eq_u32 vcc, 0, v9
    v_mov_b32 v9, 0x40000
    v_mov_b32 v7, 2176
    v_and_b32 v8, 1, v3
    v_cndmask_b32 v7, v9, v7, vcc
    v_cmp_eq_u32 vcc, 0, v8
    v_mov_b32 v9, 512
    v_and_b32 v1, 7, v2
    v_cndmask_b32 v6, v7, v6, vcc
    v_cndmask_b32 v9, 8, v9, vcc
    v_add_u32 v144, v4, v6
    v_add_u32 v145, v144, v9
    v_add_u32 v146, v145, v9
    v_add_u32 v147, v146, v9
    v_lshlrev_b32 v1, 4, v1
    v_lshl_add_u32 v1, v3, 2, v1
    v_lshrrev_b32 v5, 3, v2
    v_mul_u32_u24 v5, 640, v5
    v_add_u32 v1, 2048, v1
    v_add_u32 v121, v1, v5
    v_lshlrev_b32 v1, 2, v8
    v_lshl_add_u32 v254, v2, 4, v1
    v_lshlrev_b32 v119, 4, v252
    v_mov_b32 v120, v121
    v_mov_b32 v140, v144
    v_mov_b32 v141, v145
    v_mov_b32 v142, v146
    v_mov_b32 v143, v147
    v_mov_b32 v118, 0xdddddddd
    v_mov_b32 v117, 0x3f803f80
    v_mov_b32 v64, 0
    v_mov_b32 v65, 0
    v_mov_b32 v66, 0
    v_mov_b32 v67, 0
    v_mov_b32 v68, 0
    v_mov_b32 v69, 0
    v_mov_b32 v70, 0
    v_mov_b32 v71, 0
    v_mov_b32 v72, 0
    v_mov_b32 v73, 0
    v_mov_b32 v74, 0
    v_mov_b32 v75, 0
    v_mov_b32 v76, 0
    v_mov_b32 v77, 0
    v_mov_b32 v78, 0
    v_mov_b32 v79, 0
    v_mov_b32 v80, 0
    v_mov_b32 v81, 0
    v_mov_b32 v82, 0
    v_mov_b32 v83, 0
    v_mov_b32 v84, 0
    v_mov_b32 v85, 0
    v_mov_b32 v86, 0
    v_mov_b32 v87, 0
    v_mov_b32 v88, 0
    v_mov_b32 v89, 0
    v_mov_b32 v90, 0
    v_mov_b32 v91, 0
    v_mov_b32 v92, 0
    v_mov_b32 v93, 0
    v_mov_b32 v94, 0
    v_mov_b32 v95, 0
    s_mov_b32 s55, 0
    s_setprio 1
    s_barrier
    s_branch .Lp2_join
.Lwave4:
    v_cmp_le_u32 vcc, 64, v58
    s_and_b32 s68, vcc_lo, 15
    s_cmp_eq_u32 s68, 15
    s_cbranch_scc1 .Lcleared
    s_mov_b32 s70, 3000000
    s_mov_b32 s68, 0xf
    s_mov_b32 s69, 0x0
.Lpoll1:
    buffer_load_dword v58, v57, s[24:27], 0 offen sc1
    s_waitcnt vmcnt(0)
    v_cmp_le_u32 vcc, 64, v58
    s_and_b64 vcc, vcc, s[68:69]
    s_cmp_eq_u64 vcc, s[68:69]
    s_cbranch_scc1 .Lpolld2
    s_sub_u32 s70, s70, 1
    s_cmp_lg_u32 s70, 0
    s_cbranch_scc1 .Lpoll1
.Lpolld2:
.Lcleared:
    s_lshl_b32 s71, s4, 7
    s_add_u32 s71, s71, 14696448
    v_and_b32 v13, 31, v252
    v_lshlrev_b32 v13, 2, v13
    buffer_load_dword v14, v13, s[8:11], s71 offen sc1
    s_mov_b32 s7, s71
    v_and_b32 v1, 15, v252
    v_lshrrev_b32 v2, 4, v252
    v_lshrrev_b32 v3, 2, v1
    v_and_b32 v4, 3, v1
    v_lshl_add_u32 v3, v3, 3, v4
    v_lshrrev_b32 v6, 1, v2
    v_mul_u32_u24 v6, 20, v6
    v_and_b32 v4, 1, v2
    v_lshl_add_u32 v6, v4, 3, v6
    v_mul_u32_u24 v7, 144, v2
    s_lshr_b32 s58, s2, 5
    s_mul_i32 s58, s58, 72
    s_bfe_u32 s59, s2, 0x20002
    s_mul_i32 s59, s59, 36
    s_and_b32 s62, s2, 3
    s_mul_i32 s63, s62, 144
    s_add_u32 s63, s63, s59
    s_add_u32 s59, s59, 16
    s_mov_b64 s[64:65], 0
    s_mov_b32 s66, 16
    s_lshr_b32 s60, s50, 1
    s_lshl_b32 s60, s60, 5
    s_and_b32 s61, s50, 1
    s_lshl_b32 s61, s61, 2
    s_add_u32 s60, s60, s61
    s_add_u32 s60, s60, s58
    s_cmp_eq_u32 s50, 4
    s_cselect_b64 vcc, -1, 0
    s_cselect_b32 s61, 8, 16
    s_min_u32 s61, s61, s66
    v_cndmask_b32 v4, v3, v1, vcc
    v_add_u32 v4, s60, v4
    v_cndmask_b32 v5, v6, v7, s[64:65]
    v_add_u32 v5, s63, v5
    v_mul_u32_u24 v5, 1152, v5
    v_lshl_add_u32 v5, v4, 1, v5
    v_cmp_gt_u32 vcc, s61, v1
    v_mov_b32 v4, 0x80000000
    s_nop 0
    v_cndmask_b32 v24, v4, v5, vcc
    s_cmp_eq_u32 s50, 1
    s_cselect_b32 s67, s62, 4
    s_cmp_eq_u32 s62, 0
    s_cselect_b32 s66, 3, 2
    s_cmp_lt_u32 s50, s66
    s_cselect_b32 s66, 16, 0
    s_cmp_ge_u32 s50, 1
    s_cselect_b64 s[64:65], -1, 0
    s_cselect_b32 s71, s59, s63
    s_lshr_b32 s60, s67, 1
    s_lshl_b32 s60, s60, 5
    s_and_b32 s61, s67, 1
    s_lshl_b32 s61, s61, 2
    s_add_u32 s60, s60, s61
    s_add_u32 s60, s60, s58
    s_cmp_eq_u32 s67, 4
    s_cselect_b64 vcc, -1, 0
    s_cselect_b32 s61, 8, 16
    s_min_u32 s61, s61, s66
    v_cndmask_b32 v4, v3, v1, vcc
    v_add_u32 v4, s60, v4
    v_cndmask_b32 v5, v6, v7, s[64:65]
    v_add_u32 v5, s71, v5
    v_mul_u32_u24 v5, 1152, v5
    v_lshl_add_u32 v5, v4, 1, v5
    v_cmp_gt_u32 vcc, s61, v1
    v_mov_b32 v4, 0x80000000
    s_nop 0
    v_cndmask_b32 v25, v4, v5, vcc
    s_bitcmp1_b32 s2, 4
    s_cselect_b32 s20, s38, s32
    s_cselect_b32 s21, s39, s33
    s_mov_b32 s22, 663552
    s_mov_b32 s23, 0x00020000
    s_mov_b32 s60, 4608
    buffer_load_ushort v220, v24, s[20:23], 0 offen offset:0
    buffer_load_ushort v221, v24, s[20:23], 0 offen offset:1152
    buffer_load_ushort v222, v24, s[20:23], 0 offen offset:2304
    buffer_load_ushort v223, v24, s[20:23], 0 offen offset:3456
    buffer_load_ushort v224, v24, s[20:23], s60 offen offset:0
    buffer_load_ushort v225, v24, s[20:23], s60 offen offset:1152
    buffer_load_ushort v226, v24, s[20:23], s60 offen offset:2304
    buffer_load_ushort v227, v24, s[20:23], s60 offen offset:3456
    buffer_load_ushort v228, v25, s[20:23], 0 offen offset:0
    buffer_load_ushort v229, v25, s[20:23], 0 offen offset:1152
    buffer_load_ushort v230, v25, s[20:23], 0 offen offset:2304
    buffer_load_ushort v231, v25, s[20:23], 0 offen offset:3456
    buffer_load_ushort v232, v25, s[20:23], s60 offen offset:0
    buffer_load_ushort v233, v25, s[20:23], s60 offen offset:1152
    buffer_load_ushort v234, v25, s[20:23], s60 offen offset:2304
    buffer_load_ushort v235, v25, s[20:23], s60 offen offset:3456
    s_lshl_b32 s48, s4, 3
    s_lshr_b32 s49, s5, 2
    s_add_u32 s48, s48, s49
    s_and_b32 s49, s5, 3
    s_lshl_b32 s49, s49, 3
    s_add_u32 s49, s49, s3
    s_mul_i32 s50, s48, 229376
    s_mul_i32 s51, s49, 2304
    s_add_u32 s51, s51, s50
    s_add_u32 s51, s51, 155648
    s_lshl_b32 s52, s3, 10
    s_add_u32 s53, s50, s52
    s_mov_b32 m0, s52
    v_and_b32 v2, 15, v252
    v_lshrrev_b32 v3, 4, v252
    v_lshrrev_b32 v4, 1, v3
    v_lshlrev_b32 v4, 8, v4
    v_lshrrev_b32 v5, 2, v2
    v_lshl_add_u32 v4, v5, 5, v4
    v_and_b32 v6, 1, v2
    v_bfe_u32 v7, v2, 1, 1
    v_lshl_add_u32 v6, v6, 1, v7
    v_lshlrev_b32 v6, 3, v6
    v_add_u32 v6, 2816, v6
    v_and_b32 v9, 3, v2
    v_cmp_eq_u32 vcc, 0, v9
    v_mov_b32 v9, 0x40000
    v_mov_b32 v7, 2176
    v_and_b32 v8, 1, v3
    v_cndmask_b32 v7, v9, v7, vcc
    v_cmp_eq_u32 vcc, 0, v8
    v_mov_b32 v9, 512
    v_and_b32 v1, 7, v2
    v_cndmask_b32 v6, v7, v6, vcc
    v_cndmask_b32 v9, 8, v9, vcc
    v_add_u32 v144, v4, v6
    v_add_u32 v145, v144, v9
    v_add_u32 v146, v145, v9
    v_add_u32 v147, v146, v9
    v_lshlrev_b32 v1, 4, v1
    v_lshl_add_u32 v1, v3, 2, v1
    v_lshrrev_b32 v5, 3, v2
    v_mul_u32_u24 v5, 640, v5
    v_add_u32 v1, 2048, v1
    v_add_u32 v121, v1, v5
    v_lshlrev_b32 v1, 2, v8
    v_lshl_add_u32 v254, v2, 4, v1
    v_lshlrev_b32 v119, 4, v252
    v_mov_b32 v120, v121
    v_mov_b32 v140, v144
    v_mov_b32 v141, v145
    v_mov_b32 v142, v146
    v_mov_b32 v143, v147
    v_mov_b32 v118, 0xdddddddd
    v_mov_b32 v117, 0x3f803f80
    v_mov_b32 v64, 0
    v_mov_b32 v65, 0
    v_mov_b32 v66, 0
    v_mov_b32 v67, 0
    v_mov_b32 v68, 0
    v_mov_b32 v69, 0
    v_mov_b32 v70, 0
    v_mov_b32 v71, 0
    v_mov_b32 v72, 0
    v_mov_b32 v73, 0
    v_mov_b32 v74, 0
    v_mov_b32 v75, 0
    v_mov_b32 v76, 0
    v_mov_b32 v77, 0
    v_mov_b32 v78, 0
    v_mov_b32 v79, 0
    v_mov_b32 v80, 0
    v_mov_b32 v81, 0
    v_mov_b32 v82, 0
    v_mov_b32 v83, 0
    v_mov_b32 v84, 0
    v_mov_b32 v85, 0
    v_mov_b32 v86, 0
    v_mov_b32 v87, 0
    v_mov_b32 v88, 0
    v_mov_b32 v89, 0
    v_mov_b32 v90, 0
    v_mov_b32 v91, 0
    v_mov_b32 v92, 0
    v_mov_b32 v93, 0
    v_mov_b32 v94, 0
    v_mov_b32 v95, 0
    s_mov_b32 s55, 0
    s_setprio 1
    s_lshl_b32 s61, s5, 2
    v_mov_b32 v11, s61
    v_mov_b32 v12, s6
    s_mov_b32 s70, 3000000
    s_barrier
    s_mov_b64 exec, 1
    buffer_store_dword v12, v11, s[8:11], s7 offen
    s_mov_b64 exec, -1
.Lsync1:
    buffer_load_dword v14, v13, s[8:11], s7 offen sc1
    s_waitcnt vmcnt(0)
    v_cmp_eq_u32 vcc, s6, v14
    s_cmp_eq_u32 vcc_lo, -1
    s_cbranch_scc1 .Lp2_join
    s_sub_u32 s70, s70, 1
    s_and_b32 s68, s70, 31
    s_cbranch_scc1 .Lsync1
    s_mov_b64 exec, 1
    buffer_store_dword v12, v11, s[8:11], s7 offen offset:1024 sc1
    s_mov_b64 exec, -1
    buffer_load_dword v14, v13, s[8:11], s7 offen offset:1024 sc1
    s_waitcnt vmcnt(0)
    v_cmp_eq_u32 vcc, s6, v14
    v_cmp_eq_u32 s[68:69], 0, v14
    s_cmp_eq_u32 vcc_lo, -1
    s_cbranch_scc1 .Lp2_join
    s_or_b32 s68, s68, vcc_lo
    s_cmp_eq_u32 s68, -1
    s_cbranch_scc0 .Lsync1_far
    s_cmp_gt_u32 s70, 32
    s_cbranch_scc1 .Lsync1
.Lsync1_far:
    buffer_wbl2 sc1
    s_waitcnt vmcnt(0)
    s_add_u32 s7, s7, 2048
    s_mov_b64 exec, 1
    buffer_store_dword v12, v11, s[8:11], s7 offen sc1
    s_mov_b64 exec, -1
    s_mov_b32 s70, 3000000
    s_mov_b32 s68, 0xffffffff
    s_mov_b32 s69, 0x0
.Lpoll4:
    buffer_load_dword v14, v13, s[8:11], s7 offen sc1
    s_waitcnt vmcnt(0)
    v_cmp_ne_u32 vcc, 0, v14
    s_and_b64 vcc, vcc, s[68:69]
    s_cmp_eq_u64 vcc, s[68:69]
    s_cbranch_scc1 .Lpolld5
    s_sub_u32 s70, s70, 1
    s_cmp_lg_u32 s70, 0
    s_cbranch_scc1 .Lpoll4
.Lpolld5:
    buffer_inv sc1
    s_waitcnt vmcnt(0)
    s_branch .Lp2_join
.Lconsumer:
    s_and_b32 s50, s3, 1
    s_lshr_b32 s51, s3, 1
    s_mul_i32 s52, s5, 2
    v_mul_u32_u24 v2, 57, v252
    v_lshrrev_b32 v2, 9, v2
    v_mul_u32_u24 v3, 9, v2
    v_sub_u32 v3, v252, v3
    v_add_u32 v2, s52, v2
    v_mul_u32_u24 v4, 11, v3
    v_lshrrev_b32 v4, 5, v4
    v_mul_u32_u24 v4, 768, v4
    v_lshl_add_u32 v4, v3, 7, v4
    v_mul_u32_u24 v2, 3456, v2
    s_and_b32 s52, s4, 3
    s_lshl_b32 s52, s52, 8
    v_add3_u32 v2, v2, v4, s52
    v_cmp_gt_u32 vcc, 18, v252
    v_mov_b32 v5, 0x80000000
    v_and_b32 v3, 3, v252
    v_cndmask_b32 v2, v5, v2, vcc
    v_cmp_eq_u32 vcc, s3, v3
    s_nop 1
    v_cndmask_b32 v213, v5, v2, vcc
    s_mov_b32 s71, 221184
    s_waitcnt lgkmcnt(0)
    s_mov_b32 s8, s46
    s_mov_b32 s9, s47
    s_mov_b32 s10, 268435456
    s_mov_b32 s11, 0x00020000
    s_mov_b32 s12, s28
    s_mov_b32 s13, s29
    s_mov_b32 s14, 2359296
    s_mov_b32 s15, 0x00020000
    s_cmp_lt_u32 s4, 4
    s_cselect_b32 s16, s30, s36
    s_cselect_b32 s17, s31, s37
    s_mov_b32 s18, 1990656
    s_mov_b32 s19, 0x00020000
    s_mov_b32 s53, 0
    buffer_load_dword v214, v213, s[16:19], s53 offen
    s_mov_b32 s53, 221184
    buffer_load_dword v214, v213, s[16:19], s53 offen
    s_mov_b32 s53, 442368
    buffer_load_dword v214, v213, s[16:19], s53 offen
    s_cmp_eq_u32 s3, 3
    s_cbranch_scc0 .Lnoarrive
    s_lshl_b32 s52, s4, 7
    s_lshl_b32 s53, s5, 2
    s_add_u32 s52, s52, s53
    v_lshlrev_b32 v1, 10, v252
    v_add_u32 v1, s52, v1
    s_lshl_b32 s52, s2, 2
    s_add_u32 s52, s52, 3072
    v_mov_b32 v3, s52
    s_and_b32 s52, s5, 3
    s_lshl_b32 s52, s52, 13
    s_and_b32 s53, s4, 4
    s_lshr_b32 s54, s5, 3
    s_add_u32 s53, s53, s54
    s_lshl_b32 s53, s53, 7
    s_and_b32 s54, s4, 3
    s_lshl_b32 s54, s54, 3
    s_add_u32 s53, s53, s54
    s_and_b32 s54, s5, 4
    s_add_u32 s53, s53, s54
    s_add_u32 s52, s52, s53
    v_lshlrev_b32 v2, 10, v252
    v_add_u32 v2, s52, v2
    v_cmp_gt_u32 vcc, 3, v252
    v_mov_b32 v7, 0x80000000
    v_mov_b32 v141, 0
    v_cndmask_b32 v1, v2, v1, vcc
    v_cmp_eq_u32 vcc, 3, v252
    s_nop 1
    v_cndmask_b32 v1, v1, v3, vcc
    v_cmp_gt_u32 vcc, 12, v252
    s_nop 1
    v_cndmask_b32 v140, v7, v1, vcc
    s_mov_b32 s24, s44
    s_mov_b32 s25, s45
    s_mov_b32 s26, 256
    s_mov_b32 s27, 0x00020000
    s_mov_b32 s52, 14696448
    buffer_store_dword v141, v140, s[8:11], s52 offen sc1
    s_and_b32 s52, s2, 3
    s_lshl_b32 s52, s52, 6
    v_mov_b32 v1, 1
    s_waitcnt vmcnt(0)
    s_mov_b64 exec, 1
    buffer_atomic_add v1, v141, s[24:27], s52 offen
    s_mov_b64 exec, -1
.Lnoarrive:
    v_and_b32 v1, 15, v252
    v_lshrrev_b32 v2, 4, v252
    v_bfe_u32 v3, v252, 1, 3
    v_xor_b32 v3, v2, v3
    s_lshl_b32 s52, s51, 6
    v_add_u32 v4, s52, v1
    v_lshlrev_b32 v4, 7, v4
    v_lshl_add_u32 v4, v3, 4, v4
    v_add_u32 v207, 98304, v4
    v_xor_b32 v222, 64, v207
    s_and_b32 s52, s4, 1
    s_lshl_b32 s52, s52, 2
    s_mul_i32 s53, s50, 27
    s_add_u32 s52, s52, s53
    s_mul_i32 s53, s50, 3
    s_add_u32 s59, s53, 0
    s_cmp_ge_u32 s59, 4
    s_cselect_b32 s60, 4, 0
    s_cmp_ge_u32 s59, 2
    s_cselect_b32 s61, 6, 2
    s_cmp_eq_u32 s49, 0
    s_cselect_b32 s60, s60, s61
    s_add_u32 s62, s52, 0
    s_add_u32 s62, s62, s60
    s_add_u32 s59, s53, 1
    s_cmp_ge_u32 s59, 4
    s_cselect_b32 s60, 4, 0
    s_cmp_ge_u32 s59, 2
    s_cselect_b32 s61, 6, 2
    s_cmp_eq_u32 s49, 0
    s_cselect_b32 s60, s60, s61
    s_add_u32 s63, s52, 9
    s_add_u32 s63, s63, s60
    s_add_u32 s59, s53, 2
    s_cmp_ge_u32 s59, 4
    s_cselect_b32 s60, 4, 0
    s_cmp_ge_u32 s59, 2
    s_cselect_b32 s61, 6, 2
    s_cmp_eq_u32 s49, 0
    s_cselect_b32 s60, s60, s61
    s_add_u32 s64, s52, 18
    s_add_u32 s64, s64, s60
    v_lshrrev_b32 v3, 2, v1
    v_lshl_add_u32 v4, v2, 3, v3
    v_lshlrev_b32 v4, 9, v4
    v_bfe_u32 v5, v252, 3, 2
    v_lshlrev_b32 v5, 3, v5
    v_and_b32 v6, 4, v1
    v_and_b32 v7, 3, v1
    v_lshrrev_b32 v8, 1, v7
    v_lshl_add_u32 v8, v7, 1, v8
    v_add_u32 v8, v8, v5
    v_add_u32 v9, s62, v8
    v_and_b32 v9, 63, v9
    v_xor_b32 v9, v9, v6
    v_lshl_add_u32 v200, v9, 3, v4
    v_add_u32 v215, 65536, v200
    v_add_u32 v9, s62, v8
    v_add_u32 v9, 1, v9
    v_and_b32 v9, 63, v9
    v_xor_b32 v9, v9, v6
    v_lshl_add_u32 v201, v9, 3, v4
    v_add_u32 v216, 65536, v201
    v_add_u32 v9, s63, v8
    v_and_b32 v9, 63, v9
    v_xor_b32 v9, v9, v6
    v_lshl_add_u32 v202, v9, 3, v4
    v_add_u32 v217, 65536, v202
    v_add_u32 v9, s63, v8
    v_add_u32 v9, 1, v9
    v_and_b32 v9, 63, v9
    v_xor_b32 v9, v9, v6
    v_lshl_add_u32 v203, v9, 3, v4
    v_add_u32 v218, 65536, v203
    v_add_u32 v9, s64, v8
    v_and_b32 v9, 63, v9
    v_xor_b32 v9, v9, v6
    v_lshl_add_u32 v204, v9, 3, v4
    v_add_u32 v219, 65536, v204
    v_add_u32 v9, s64, v8
    v_add_u32 v9, 1, v9
    v_and_b32 v9, 63, v9
    v_xor_b32 v9, v9, v6
    v_lshl_add_u32 v205, v9, 3, v4
    v_add_u32 v220, 65536, v205
    v_mov_b32 v9, s64
    v_mov_b32 v3, s63
    v_cmp_eq_u32 vcc, 1, v7
    s_nop 1
    v_cndmask_b32 v9, v9, v3, vcc
    v_mov_b32 v3, s62
    v_cmp_eq_u32 vcc, 0, v7
    s_nop 1
    v_cndmask_b32 v9, v9, v3, vcc
    v_add3_u32 v9, v9, v5, 4
    v_and_b32 v9, 63, v9
    v_xor_b32 v9, v9, v6
    v_lshl_add_u32 v206, v9, 3, v4
    v_cmp_eq_u32 vcc, 3, v7
    v_mov_b32 v3, 0x40000
    s_nop 0
    v_cndmask_b32 v206, v206, v3, vcc
    v_add_u32 v221, 65536, v206
    v_lshrrev_b32 v3, 1, v2
    s_mov_b32 s52, 229376
    v_mul_lo_u32 v3, v3, s52
    v_and_b32 v4, 1, v2
    v_lshl_add_u32 v5, v4, 9, v3
    v_lshl_add_u32 v208, v1, 4, v5
    v_lshl_add_u32 v5, v4, 4, v3
    v_lshl_add_u32 v209, v1, 5, v5
    s_mul_i32 s52, s49, 12
    s_mul_i32 s53, s50, 6
    s_add_u32 s54, s52, s53
    s_lshl_b32 s55, s48, 1
    s_add_u32 s55, s55, s51
    s_lshl_b32 s56, s4, 3
    v_lshl_add_u32 v3, v2, 1, s54
    v_lshrrev_b32 v4, 3, v3
    v_and_b32 v3, 7, v3
    v_add_u32 v3, s56, v3
    s_mov_b32 s52, 229376
    v_mul_lo_u32 v3, v3, s52
    s_mul_i32 s57, s55, 2304
    s_add_u32 s57, s57, 155648
    s_mul_i32 s58, s55, 4864
    v_lshrrev_b32 v5, 3, v1
    v_mul_u32_u24 v5, 512, v5
    v_add_u32 v5, s58, v5
    v_mov_b32 v6, s57
    v_cmp_eq_u32 vcc, 0, v4
    v_mov_b32 v7, 0x3eae1a93
    s_nop 0
    v_cndmask_b32 v5, v5, v6, vcc
    v_cndmask_b32 v212, 1.0, v7, vcc
    v_add_u32 v5, v5, v3
    v_lshl_add_u32 v5, v1, 4, v5
    v_add_u32 v210, 2048, v5
    v_lshlrev_b32 v6, 5, v1
    v_add3_u32 v6, v6, v3, s58
    v_add_u32 v211, 2176, v6
    v_mov_b32 v7, 0x80000000
    v_cmp_eq_u32 vcc, 2, v4
    s_nop 1
    v_cndmask_b32 v210, v210, v7, vcc
    v_cndmask_b32 v211, v7, v211, vcc
    v_cmp_eq_u32 vcc, 3, v2
    s_nop 1
    v_cndmask_b32 v210, v210, v7, vcc
    v_cndmask_b32 v211, v211, v7, vcc
    s_barrier
    ds_read_b128 v[112:115], v207 offset:0
    ds_read_b128 v[116:119], v207 offset:2048
    ds_read_b64_tr_b16 v[128:129], v200 offset:0
    ds_read_b64_tr_b16 v[130:131], v200 offset:2048
    ds_read_b128 v[120:123], v207 offset:4096
    ds_read_b128 v[124:127], v207 offset:6144
    ds_read_b64_tr_b16 v[132:133], v201 offset:0
    ds_read_b64_tr_b16 v[134:135], v201 offset:2048
    ds_read_b64_tr_b16 v[136:137], v202 offset:0
    ds_read_b64_tr_b16 v[138:139], v202 offset:2048
    ds_read_b64_tr_b16 v[140:141], v203 offset:0
    ds_read_b64_tr_b16 v[142:143], v203 offset:2048
    ds_read_b64_tr_b16 v[144:145], v204 offset:0
    ds_read_b64_tr_b16 v[146:147], v204 offset:2048
    ds_read_b64_tr_b16 v[148:149], v205 offset:0
    ds_read_b64_tr_b16 v[150:151], v205 offset:2048
    ds_read_b64_tr_b16 v[152:153], v206 offset:0
    ds_read_b64_tr_b16 v[154:155], v206 offset:2048
    s_waitcnt lgkmcnt(0)
    s_mov_b32 s53, 663552
    buffer_load_dword v214, v213, s[16:19], s53 offen
    v_mfma_f32_16x16x32_bf16 v[0:3], v[128:131], v[112:115], 0
    ds_read_b128 v[156:159], v222 offset:0
    v_mfma_f32_16x16x32_bf16 v[28:31], v[128:131], v[116:119], 0
    ds_read_b128 v[160:163], v222 offset:2048
    v_mfma_f32_16x16x32_bf16 v[56:59], v[128:131], v[120:123], 0
    ds_read_b64_tr_b16 v[172:173], v200 offset:16384
    v_mfma_f32_16x16x32_bf16 v[84:87], v[128:131], v[124:127], 0
    ds_read_b64_tr_b16 v[174:175], v200 offset:18432
    v_mfma_f32_16x16x32_bf16 v[4:7], v[132:135], v[112:115], 0
    ds_read_b128 v[164:167], v222 offset:4096
    v_mfma_f32_16x16x32_bf16 v[32:35], v[132:135], v[116:119], 0
    ds_read_b128 v[168:171], v222 offset:6144
    v_mfma_f32_16x16x32_bf16 v[60:63], v[132:135], v[120:123], 0
    ds_read_b64_tr_b16 v[176:177], v201 offset:16384
    v_mfma_f32_16x16x32_bf16 v[88:91], v[132:135], v[124:127], 0
    ds_read_b64_tr_b16 v[178:179], v201 offset:18432
    v_mfma_f32_16x16x32_bf16 v[8:11], v[136:139], v[112:115], 0
    ds_read_b64_tr_b16 v[180:181], v202 offset:16384
    v_mfma_f32_16x16x32_bf16 v[36:39], v[136:139], v[116:119], 0
    ds_read_b64_tr_b16 v[182:183], v202 offset:18432
    v_mfma_f32_16x16x32_bf16 v[64:67], v[136:139], v[120:123], 0
    ds_read_b64_tr_b16 v[184:185], v203 offset:16384
    v_mfma_f32_16x16x32_bf16 v[92:95], v[136:139], v[124:127], 0
    ds_read_b64_tr_b16 v[186:187], v203 offset:18432
    v_mfma_f32_16x16x32_bf16 v[12:15], v[140:143], v[112:115], 0
    ds_read_b64_tr_b16 v[188:189], v204 offset:16384
    v_mfma_f32_16x16x32_bf16 v[40:43], v[140:143], v[116:119], 0
    ds_read_b64_tr_b16 v[190:191], v204 offset:18432
    v_mfma_f32_16x16x32_bf16 v[68:71], v[140:143], v[120:123], 0
    ds_read_b64_tr_b16 v[192:193], v205 offset:16384
    v_mfma_f32_16x16x32_bf16 v[96:99], v[140:143], v[124:127], 0
    ds_read_b64_tr_b16 v[194:195], v205 offset:18432
    v_mfma_f32_16x16x32_bf16 v[16:19], v[144:147], v[112:115], 0
    ds_read_b64_tr_b16 v[196:197], v206 offset:16384
    v_mfma_f32_16x16x32_bf16 v[44:47], v[144:147], v[116:119], 0
    ds_read_b64_tr_b16 v[198:199], v206 offset:18432
    v_mfma_f32_16x16x32_bf16 v[72:75], v[144:147], v[120:123], 0
    v_mfma_f32_16x16x32_bf16 v[100:103], v[144:147], v[124:127], 0
    v_mfma_f32_16x16x32_bf16 v[20:23], v[148:151], v[112:115], 0
    v_mfma_f32_16x16x32_bf16 v[48:51], v[148:151], v[116:119], 0
    v_mfma_f32_16x16x32_bf16 v[76:79], v[148:151], v[120:123], 0
    v_mfma_f32_16x16x32_bf16 v[104:107], v[148:151], v[124:127], 0
    v_mfma_f32_16x16x32_bf16 v[24:27], v[152:155], v[112:115], 0
    v_mfma_f32_16x16x32_bf16 v[52:55], v[152:155], v[116:119], 0
    v_mfma_f32_16x16x32_bf16 v[80:83], v[152:155], v[120:123], 0
    v_mfma_f32_16x16x32_bf16 v[108:111], v[152:155], v[124:127], 0
    s_waitcnt lgkmcnt(0)
    s_barrier
    s_mov_b32 s53, 884736
    buffer_load_dword v214, v213, s[16:19], s53 offen
    v_mfma_f32_16x16x32_bf16 v[0:3], v[172:175], v[156:159], v[0:3]
    ds_read_b128 v[112:115], v207 offset:16384
    v_mfma_f32_16x16x32_bf16 v[28:31], v[172:175], v[160:163], v[28:31]
    ds_read_b128 v[116:119], v207 offset:18432
    v_mfma_f32_16x16x32_bf16 v[56:59], v[172:175], v[164:167], v[56:59]
    ds_read_b64_tr_b16 v[128:129], v200 offset:32768
    v_mfma_f32_16x16x32_bf16 v[84:87], v[172:175], v[168:171], v[84:87]
    ds_read_b64_tr_b16 v[130:131], v200 offset:34816
    v_mfma_f32_16x16x32_bf16 v[4:7], v[176:179], v[156:159], v[4:7]
    ds_read_b128 v[120:123], v207 offset:20480
    v_mfma_f32_16x16x32_bf16 v[32:35], v[176:179], v[160:163], v[32:35]
    ds_read_b128 v[124:127], v207 offset:22528
    v_mfma_f32_16x16x32_bf16 v[60:63], v[176:179], v[164:167], v[60:63]
    ds_read_b64_tr_b16 v[132:133], v201 offset:32768
    v_mfma_f32_16x16x32_bf16 v[88:91], v[176:179], v[168:171], v[88:91]
    ds_read_b64_tr_b16 v[134:135], v201 offset:34816
    v_mfma_f32_16x16x32_bf16 v[8:11], v[180:183], v[156:159], v[8:11]
    ds_read_b64_tr_b16 v[136:137], v202 offset:32768
    v_mfma_f32_16x16x32_bf16 v[36:39], v[180:183], v[160:163], v[36:39]
    ds_read_b64_tr_b16 v[138:139], v202 offset:34816
    v_mfma_f32_16x16x32_bf16 v[64:67], v[180:183], v[164:167], v[64:67]
    ds_read_b64_tr_b16 v[140:141], v203 offset:32768
    v_mfma_f32_16x16x32_bf16 v[92:95], v[180:183], v[168:171], v[92:95]
    ds_read_b64_tr_b16 v[142:143], v203 offset:34816
    v_mfma_f32_16x16x32_bf16 v[12:15], v[184:187], v[156:159], v[12:15]
    ds_read_b64_tr_b16 v[144:145], v204 offset:32768
    v_mfma_f32_16x16x32_bf16 v[40:43], v[184:187], v[160:163], v[40:43]
    ds_read_b64_tr_b16 v[146:147], v204 offset:34816
    v_mfma_f32_16x16x32_bf16 v[68:71], v[184:187], v[164:167], v[68:71]
    ds_read_b64_tr_b16 v[148:149], v205 offset:32768
    v_mfma_f32_16x16x32_bf16 v[96:99], v[184:187], v[168:171], v[96:99]
    ds_read_b64_tr_b16 v[150:151], v205 offset:34816
    v_mfma_f32_16x16x32_bf16 v[16:19], v[188:191], v[156:159], v[16:19]
    ds_read_b64_tr_b16 v[152:153], v206 offset:32768
    v_mfma_f32_16x16x32_bf16 v[44:47], v[188:191], v[160:163], v[44:47]
    ds_read_b64_tr_b16 v[154:155], v206 offset:34816
    v_mfma_f32_16x16x32_bf16 v[72:75], v[188:191], v[164:167], v[72:75]
    v_mfma_f32_16x16x32_bf16 v[100:103], v[188:191], v[168:171], v[100:103]
    v_mfma_f32_16x16x32_bf16 v[20:23], v[192:195], v[156:159], v[20:23]
    v_mfma_f32_16x16x32_bf16 v[48:51], v[192:195], v[160:163], v[48:51]
    v_mfma_f32_16x16x32_bf16 v[76:79], v[192:195], v[164:167], v[76:79]
    v_mfma_f32_16x16x32_bf16 v[104:107], v[192:195], v[168:171], v[104:107]
    v_mfma_f32_16x16x32_bf16 v[24:27], v[196:199], v[156:159], v[24:27]
    v_mfma_f32_16x16x32_bf16 v[52:55], v[196:199], v[160:163], v[52:55]
    v_mfma_f32_16x16x32_bf16 v[80:83], v[196:199], v[164:167], v[80:83]
    v_mfma_f32_16x16x32_bf16 v[108:111], v[196:199], v[168:171], v[108:111]
    s_waitcnt lgkmcnt(0)
    v_mfma_f32_16x16x32_bf16 v[0:3], v[128:131], v[112:115], v[0:3]
    ds_read_b128 v[156:159], v222 offset:16384
    v_mfma_f32_16x16x32_bf16 v[28:31], v[128:131], v[116:119], v[28:31]
    ds_read_b128 v[160:163], v222 offset:18432
    v_mfma_f32_16x16x32_bf16 v[56:59], v[128:131], v[120:123], v[56:59]
    ds_read_b64_tr_b16 v[172:173], v200 offset:49152
    v_mfma_f32_16x16x32_bf16 v[84:87], v[128:131], v[124:127], v[84:87]
    ds_read_b64_tr_b16 v[174:175], v200 offset:51200
    v_mfma_f32_16x16x32_bf16 v[4:7], v[132:135], v[112:115], v[4:7]
    ds_read_b128 v[164:167], v222 offset:20480
    v_mfma_f32_16x16x32_bf16 v[32:35], v[132:135], v[116:119], v[32:35]
    ds_read_b128 v[168:171], v222 offset:22528
    v_mfma_f32_16x16x32_bf16 v[60:63], v[132:135], v[120:123], v[60:63]
    ds_read_b64_tr_b16 v[176:177], v201 offset:49152
    v_mfma_f32_16x16x32_bf16 v[88:91], v[132:135], v[124:127], v[88:91]
    ds_read_b64_tr_b16 v[178:179], v201 offset:51200
    v_mfma_f32_16x16x32_bf16 v[8:11], v[136:139], v[112:115], v[8:11]
    ds_read_b64_tr_b16 v[180:181], v202 offset:49152
    v_mfma_f32_16x16x32_bf16 v[36:39], v[136:139], v[116:119], v[36:39]
    ds_read_b64_tr_b16 v[182:183], v202 offset:51200
    v_mfma_f32_16x16x32_bf16 v[64:67], v[136:139], v[120:123], v[64:67]
    ds_read_b64_tr_b16 v[184:185], v203 offset:49152
    v_mfma_f32_16x16x32_bf16 v[92:95], v[136:139], v[124:127], v[92:95]
    ds_read_b64_tr_b16 v[186:187], v203 offset:51200
    v_mfma_f32_16x16x32_bf16 v[12:15], v[140:143], v[112:115], v[12:15]
    ds_read_b64_tr_b16 v[188:189], v204 offset:49152
    v_mfma_f32_16x16x32_bf16 v[40:43], v[140:143], v[116:119], v[40:43]
    ds_read_b64_tr_b16 v[190:191], v204 offset:51200
    v_mfma_f32_16x16x32_bf16 v[68:71], v[140:143], v[120:123], v[68:71]
    ds_read_b64_tr_b16 v[192:193], v205 offset:49152
    v_mfma_f32_16x16x32_bf16 v[96:99], v[140:143], v[124:127], v[96:99]
    ds_read_b64_tr_b16 v[194:195], v205 offset:51200
    v_mfma_f32_16x16x32_bf16 v[16:19], v[144:147], v[112:115], v[16:19]
    ds_read_b64_tr_b16 v[196:197], v206 offset:49152
    v_mfma_f32_16x16x32_bf16 v[44:47], v[144:147], v[116:119], v[44:47]
    ds_read_b64_tr_b16 v[198:199], v206 offset:51200
    v_mfma_f32_16x16x32_bf16 v[72:75], v[144:147], v[120:123], v[72:75]
    v_mfma_f32_16x16x32_bf16 v[100:103], v[144:147], v[124:127], v[100:103]
    v_mfma_f32_16x16x32_bf16 v[20:23], v[148:151], v[112:115], v[20:23]
    v_mfma_f32_16x16x32_bf16 v[48:51], v[148:151], v[116:119], v[48:51]
    v_mfma_f32_16x16x32_bf16 v[76:79], v[148:151], v[120:123], v[76:79]
    v_mfma_f32_16x16x32_bf16 v[104:107], v[148:151], v[124:127], v[104:107]
    v_mfma_f32_16x16x32_bf16 v[24:27], v[152:155], v[112:115], v[24:27]
    v_mfma_f32_16x16x32_bf16 v[52:55], v[152:155], v[116:119], v[52:55]
    v_mfma_f32_16x16x32_bf16 v[80:83], v[152:155], v[120:123], v[80:83]
    v_mfma_f32_16x16x32_bf16 v[108:111], v[152:155], v[124:127], v[108:111]
    s_waitcnt lgkmcnt(0)
    s_barrier
    s_mov_b32 s53, 1105920
    buffer_load_dword v214, v213, s[16:19], s53 offen
    v_mfma_f32_16x16x32_bf16 v[0:3], v[172:175], v[156:159], v[0:3]
    ds_read_b128 v[112:115], v207 offset:32768
    v_mfma_f32_16x16x32_bf16 v[28:31], v[172:175], v[160:163], v[28:31]
    ds_read_b128 v[116:119], v207 offset:34816
    v_mfma_f32_16x16x32_bf16 v[56:59], v[172:175], v[164:167], v[56:59]
    ds_read_b64_tr_b16 v[128:129], v215 offset:0
    v_mfma_f32_16x16x32_bf16 v[84:87], v[172:175], v[168:171], v[84:87]
    ds_read_b64_tr_b16 v[130:131], v215 offset:2048
    v_mfma_f32_16x16x32_bf16 v[4:7], v[176:179], v[156:159], v[4:7]
    ds_read_b128 v[120:123], v207 offset:36864
    v_mfma_f32_16x16x32_bf16 v[32:35], v[176:179], v[160:163], v[32:35]
    ds_read_b128 v[124:127], v207 offset:38912
    v_mfma_f32_16x16x32_bf16 v[60:63], v[176:179], v[164:167], v[60:63]
    ds_read_b64_tr_b16 v[132:133], v216 offset:0
    v_mfma_f32_16x16x32_bf16 v[88:91], v[176:179], v[168:171], v[88:91]
    ds_read_b64_tr_b16 v[134:135], v216 offset:2048
    v_mfma_f32_16x16x32_bf16 v[8:11], v[180:183], v[156:159], v[8:11]
    ds_read_b64_tr_b16 v[136:137], v217 offset:0
    v_mfma_f32_16x16x32_bf16 v[36:39], v[180:183], v[160:163], v[36:39]
    ds_read_b64_tr_b16 v[138:139], v217 offset:2048
    v_mfma_f32_16x16x32_bf16 v[64:67], v[180:183], v[164:167], v[64:67]
    ds_read_b64_tr_b16 v[140:141], v218 offset:0
    v_mfma_f32_16x16x32_bf16 v[92:95], v[180:183], v[168:171], v[92:95]
    ds_read_b64_tr_b16 v[142:143], v218 offset:2048
    v_mfma_f32_16x16x32_bf16 v[12:15], v[184:187], v[156:159], v[12:15]
    ds_read_b64_tr_b16 v[144:145], v219 offset:0
    v_mfma_f32_16x16x32_bf16 v[40:43], v[184:187], v[160:163], v[40:43]
    ds_read_b64_tr_b16 v[146:147], v219 offset:2048
    v_mfma_f32_16x16x32_bf16 v[68:71], v[184:187], v[164:167], v[68:71]
    ds_read_b64_tr_b16 v[148:149], v220 offset:0
    v_mfma_f32_16x16x32_bf16 v[96:99], v[184:187], v[168:171], v[96:99]
    ds_read_b64_tr_b16 v[150:151], v220 offset:2048
    v_mfma_f32_16x16x32_bf16 v[16:19], v[188:191], v[156:159], v[16:19]
    ds_read_b64_tr_b16 v[152:153], v221 offset:0
    v_mfma_f32_16x16x32_bf16 v[44:47], v[188:191], v[160:163], v[44:47]
    ds_read_b64_tr_b16 v[154:155], v221 offset:2048
    v_mfma_f32_16x16x32_bf16 v[72:75], v[188:191], v[164:167], v[72:75]
    v_mfma_f32_16x16x32_bf16 v[100:103], v[188:191], v[168:171], v[100:103]
    v_mfma_f32_16x16x32_bf16 v[20:23], v[192:195], v[156:159], v[20:23]
    v_mfma_f32_16x16x32_bf16 v[48:51], v[192:195], v[160:163], v[48:51]
    v_mfma_f32_16x16x32_bf16 v[76:79], v[192:195], v[164:167], v[76:79]
    v_mfma_f32_16x16x32_bf16 v[104:107], v[192:195], v[168:171], v[104:107]
    v_mfma_f32_16x16x32_bf16 v[24:27], v[196:199], v[156:159], v[24:27]
    v_mfma_f32_16x16x32_bf16 v[52:55], v[196:199], v[160:163], v[52:55]
    v_mfma_f32_16x16x32_bf16 v[80:83], v[196:199], v[164:167], v[80:83]
    v_mfma_f32_16x16x32_bf16 v[108:111], v[196:199], v[168:171], v[108:111]
    s_waitcnt lgkmcnt(0)
    v_mfma_f32_16x16x32_bf16 v[0:3], v[128:131], v[112:115], v[0:3]
    ds_read_b128 v[156:159], v222 offset:32768
    v_mfma_f32_16x16x32_bf16 v[28:31], v[128:131], v[116:119], v[28:31]
    ds_read_b128 v[160:163], v222 offset:34816
    v_mfma_f32_16x16x32_bf16 v[56:59], v[128:131], v[120:123], v[56:59]
    ds_read_b64_tr_b16 v[172:173], v215 offset:16384
    v_mfma_f32_16x16x32_bf16 v[84:87], v[128:131], v[124:127], v[84:87]
    ds_read_b64_tr_b16 v[174:175], v215 offset:18432
    v_mfma_f32_16x16x32_bf16 v[4:7], v[132:135], v[112:115], v[4:7]
    ds_read_b128 v[164:167], v222 offset:36864
    v_mfma_f32_16x16x32_bf16 v[32:35], v[132:135], v[116:119], v[32:35]
    ds_read_b128 v[168:171], v222 offset:38912
    v_mfma_f32_16x16x32_bf16 v[60:63], v[132:135], v[120:123], v[60:63]
    ds_read_b64_tr_b16 v[176:177], v216 offset:16384
    v_mfma_f32_16x16x32_bf16 v[88:91], v[132:135], v[124:127], v[88:91]
    ds_read_b64_tr_b16 v[178:179], v216 offset:18432
    v_mfma_f32_16x16x32_bf16 v[8:11], v[136:139], v[112:115], v[8:11]
    ds_read_b64_tr_b16 v[180:181], v217 offset:16384
    v_mfma_f32_16x16x32_bf16 v[36:39], v[136:139], v[116:119], v[36:39]
    ds_read_b64_tr_b16 v[182:183], v217 offset:18432
    v_mfma_f32_16x16x32_bf16 v[64:67], v[136:139], v[120:123], v[64:67]
    ds_read_b64_tr_b16 v[184:185], v218 offset:16384
    v_mfma_f32_16x16x32_bf16 v[92:95], v[136:139], v[124:127], v[92:95]
    ds_read_b64_tr_b16 v[186:187], v218 offset:18432
    v_mfma_f32_16x16x32_bf16 v[12:15], v[140:143], v[112:115], v[12:15]
    ds_read_b64_tr_b16 v[188:189], v219 offset:16384
    v_mfma_f32_16x16x32_bf16 v[40:43], v[140:143], v[116:119], v[40:43]
    ds_read_b64_tr_b16 v[190:191], v219 offset:18432
    v_mfma_f32_16x16x32_bf16 v[68:71], v[140:143], v[120:123], v[68:71]
    ds_read_b64_tr_b16 v[192:193], v220 offset:16384
    v_mfma_f32_16x16x32_bf16 v[96:99], v[140:143], v[124:127], v[96:99]
    ds_read_b64_tr_b16 v[194:195], v220 offset:18432
    v_mfma_f32_16x16x32_bf16 v[16:19], v[144:147], v[112:115], v[16:19]
    ds_read_b64_tr_b16 v[196:197], v221 offset:16384
    v_mfma_f32_16x16x32_bf16 v[44:47], v[144:147], v[116:119], v[44:47]
    ds_read_b64_tr_b16 v[198:199], v221 offset:18432
    v_mfma_f32_16x16x32_bf16 v[72:75], v[144:147], v[120:123], v[72:75]
    v_mfma_f32_16x16x32_bf16 v[100:103], v[144:147], v[124:127], v[100:103]
    v_mfma_f32_16x16x32_bf16 v[20:23], v[148:151], v[112:115], v[20:23]
    v_mfma_f32_16x16x32_bf16 v[48:51], v[148:151], v[116:119], v[48:51]
    v_mfma_f32_16x16x32_bf16 v[76:79], v[148:151], v[120:123], v[76:79]
    v_mfma_f32_16x16x32_bf16 v[104:107], v[148:151], v[124:127], v[104:107]
    v_mfma_f32_16x16x32_bf16 v[24:27], v[152:155], v[112:115], v[24:27]
    v_mfma_f32_16x16x32_bf16 v[52:55], v[152:155], v[116:119], v[52:55]
    v_mfma_f32_16x16x32_bf16 v[80:83], v[152:155], v[120:123], v[80:83]
    v_mfma_f32_16x16x32_bf16 v[108:111], v[152:155], v[124:127], v[108:111]
    s_waitcnt lgkmcnt(0)
    s_barrier
    s_mov_b32 s53, 1327104
    buffer_load_dword v214, v213, s[16:19], s53 offen
    v_mfma_f32_16x16x32_bf16 v[0:3], v[172:175], v[156:159], v[0:3]
    ds_read_b128 v[112:115], v207 offset:0
    v_mfma_f32_16x16x32_bf16 v[28:31], v[172:175], v[160:163], v[28:31]
    ds_read_b128 v[116:119], v207 offset:2048
    v_mfma_f32_16x16x32_bf16 v[56:59], v[172:175], v[164:167], v[56:59]
    ds_read_b64_tr_b16 v[128:129], v200 offset:0
    v_mfma_f32_16x16x32_bf16 v[84:87], v[172:175], v[168:171], v[84:87]
    ds_read_b64_tr_b16 v[130:131], v200 offset:2048
    v_mfma_f32_16x16x32_bf16 v[4:7], v[176:179], v[156:159], v[4:7]
    ds_read_b128 v[120:123], v207 offset:4096
    v_mfma_f32_16x16x32_bf16 v[32:35], v[176:179], v[160:163], v[32:35]
    ds_read_b128 v[124:127], v207 offset:6144
    v_mfma_f32_16x16x32_bf16 v[60:63], v[176:179], v[164:167], v[60:63]
    ds_read_b64_tr_b16 v[132:133], v201 offset:0
    v_mfma_f32_16x16x32_bf16 v[88:91], v[176:179], v[168:171], v[88:91]
    ds_read_b64_tr_b16 v[134:135], v201 offset:2048
    v_mfma_f32_16x16x32_bf16 v[8:11], v[180:183], v[156:159], v[8:11]
    ds_read_b64_tr_b16 v[136:137], v202 offset:0
    v_mfma_f32_16x16x32_bf16 v[36:39], v[180:183], v[160:163], v[36:39]
    ds_read_b64_tr_b16 v[138:139], v202 offset:2048
    v_mfma_f32_16x16x32_bf16 v[64:67], v[180:183], v[164:167], v[64:67]
    ds_read_b64_tr_b16 v[140:141], v203 offset:0
    v_mfma_f32_16x16x32_bf16 v[92:95], v[180:183], v[168:171], v[92:95]
    ds_read_b64_tr_b16 v[142:143], v203 offset:2048
    v_mfma_f32_16x16x32_bf16 v[12:15], v[184:187], v[156:159], v[12:15]
    ds_read_b64_tr_b16 v[144:145], v204 offset:0
    v_mfma_f32_16x16x32_bf16 v[40:43], v[184:187], v[160:163], v[40:43]
    ds_read_b64_tr_b16 v[146:147], v204 offset:2048
    v_mfma_f32_16x16x32_bf16 v[68:71], v[184:187], v[164:167], v[68:71]
    ds_read_b64_tr_b16 v[148:149], v205 offset:0
    v_mfma_f32_16x16x32_bf16 v[96:99], v[184:187], v[168:171], v[96:99]
    ds_read_b64_tr_b16 v[150:151], v205 offset:2048
    v_mfma_f32_16x16x32_bf16 v[16:19], v[188:191], v[156:159], v[16:19]
    ds_read_b64_tr_b16 v[152:153], v206 offset:0
    v_mfma_f32_16x16x32_bf16 v[44:47], v[188:191], v[160:163], v[44:47]
    ds_read_b64_tr_b16 v[154:155], v206 offset:2048
    v_mfma_f32_16x16x32_bf16 v[72:75], v[188:191], v[164:167], v[72:75]
    v_mfma_f32_16x16x32_bf16 v[100:103], v[188:191], v[168:171], v[100:103]
    v_mfma_f32_16x16x32_bf16 v[20:23], v[192:195], v[156:159], v[20:23]
    v_mfma_f32_16x16x32_bf16 v[48:51], v[192:195], v[160:163], v[48:51]
    v_mfma_f32_16x16x32_bf16 v[76:79], v[192:195], v[164:167], v[76:79]
    v_mfma_f32_16x16x32_bf16 v[104:107], v[192:195], v[168:171], v[104:107]
    v_mfma_f32_16x16x32_bf16 v[24:27], v[196:199], v[156:159], v[24:27]
    v_mfma_f32_16x16x32_bf16 v[52:55], v[196:199], v[160:163], v[52:55]
    v_mfma_f32_16x16x32_bf16 v[80:83], v[196:199], v[164:167], v[80:83]
    v_mfma_f32_16x16x32_bf16 v[108:111], v[196:199], v[168:171], v[108:111]
    s_waitcnt lgkmcnt(0)
    v_mfma_f32_16x16x32_bf16 v[0:3], v[128:131], v[112:115], v[0:3]
    ds_read_b128 v[156:159], v222 offset:0
    v_mfma_f32_16x16x32_bf16 v[28:31], v[128:131], v[116:119], v[28:31]
    ds_read_b128 v[160:163], v222 offset:2048
    v_mfma_f32_16x16x32_bf16 v[56:59], v[128:131], v[120:123], v[56:59]
    ds_read_b64_tr_b16 v[172:173], v200 offset:16384
    v_mfma_f32_16x16x32_bf16 v[84:87], v[128:131], v[124:127], v[84:87]
    ds_read_b64_tr_b16 v[174:175], v200 offset:18432
    v_mfma_f32_16x16x32_bf16 v[4:7], v[132:135], v[112:115], v[4:7]
    ds_read_b128 v[164:167], v222 offset:4096
    v_mfma_f32_16x16x32_bf16 v[32:35], v[132:135], v[116:119], v[32:35]
    ds_read_b128 v[168:171], v222 offset:6144
    v_mfma_f32_16x16x32_bf16 v[60:63], v[132:135], v[120:123], v[60:63]
    ds_read_b64_tr_b16 v[176:177], v201 offset:16384
    v_mfma_f32_16x16x32_bf16 v[88:91], v[132:135], v[124:127], v[88:91]
    ds_read_b64_tr_b16 v[178:179], v201 offset:18432
    v_mfma_f32_16x16x32_bf16 v[8:11], v[136:139], v[112:115], v[8:11]
    ds_read_b64_tr_b16 v[180:181], v202 offset:16384
    v_mfma_f32_16x16x32_bf16 v[36:39], v[136:139], v[116:119], v[36:39]
    ds_read_b64_tr_b16 v[182:183], v202 offset:18432
    v_mfma_f32_16x16x32_bf16 v[64:67], v[136:139], v[120:123], v[64:67]
    ds_read_b64_tr_b16 v[184:185], v203 offset:16384
    v_mfma_f32_16x16x32_bf16 v[92:95], v[136:139], v[124:127], v[92:95]
    ds_read_b64_tr_b16 v[186:187], v203 offset:18432
    v_mfma_f32_16x16x32_bf16 v[12:15], v[140:143], v[112:115], v[12:15]
    ds_read_b64_tr_b16 v[188:189], v204 offset:16384
    v_mfma_f32_16x16x32_bf16 v[40:43], v[140:143], v[116:119], v[40:43]
    ds_read_b64_tr_b16 v[190:191], v204 offset:18432
    v_mfma_f32_16x16x32_bf16 v[68:71], v[140:143], v[120:123], v[68:71]
    ds_read_b64_tr_b16 v[192:193], v205 offset:16384
    v_mfma_f32_16x16x32_bf16 v[96:99], v[140:143], v[124:127], v[96:99]
    ds_read_b64_tr_b16 v[194:195], v205 offset:18432
    v_mfma_f32_16x16x32_bf16 v[16:19], v[144:147], v[112:115], v[16:19]
    ds_read_b64_tr_b16 v[196:197], v206 offset:16384
    v_mfma_f32_16x16x32_bf16 v[44:47], v[144:147], v[116:119], v[44:47]
    ds_read_b64_tr_b16 v[198:199], v206 offset:18432
    v_mfma_f32_16x16x32_bf16 v[72:75], v[144:147], v[120:123], v[72:75]
    v_mfma_f32_16x16x32_bf16 v[100:103], v[144:147], v[124:127], v[100:103]
    v_mfma_f32_16x16x32_bf16 v[20:23], v[148:151], v[112:115], v[20:23]
    v_mfma_f32_16x16x32_bf16 v[48:51], v[148:151], v[116:119], v[48:51]
    v_mfma_f32_16x16x32_bf16 v[76:79], v[148:151], v[120:123], v[76:79]
    v_mfma_f32_16x16x32_bf16 v[104:107], v[148:151], v[124:127], v[104:107]
    v_mfma_f32_16x16x32_bf16 v[24:27], v[152:155], v[112:115], v[24:27]
    v_mfma_f32_16x16x32_bf16 v[52:55], v[152:155], v[116:119], v[52:55]
    v_mfma_f32_16x16x32_bf16 v[80:83], v[152:155], v[120:123], v[80:83]
    v_mfma_f32_16x16x32_bf16 v[108:111], v[152:155], v[124:127], v[108:111]
    s_waitcnt lgkmcnt(0)
    s_barrier
    s_mov_b32 s53, 1548288
    buffer_load_dword v214, v213, s[16:19], s53 offen
    v_mfma_f32_16x16x32_bf16 v[0:3], v[172:175], v[156:159], v[0:3]
    ds_read_b128 v[112:115], v207 offset:16384
    v_mfma_f32_16x16x32_bf16 v[28:31], v[172:175], v[160:163], v[28:31]
    ds_read_b128 v[116:119], v207 offset:18432
    v_mfma_f32_16x16x32_bf16 v[56:59], v[172:175], v[164:167], v[56:59]
    ds_read_b64_tr_b16 v[128:129], v200 offset:32768
    v_mfma_f32_16x16x32_bf16 v[84:87], v[172:175], v[168:171], v[84:87]
    ds_read_b64_tr_b16 v[130:131], v200 offset:34816
    v_mfma_f32_16x16x32_bf16 v[4:7], v[176:179], v[156:159], v[4:7]
    ds_read_b128 v[120:123], v207 offset:20480
    v_mfma_f32_16x16x32_bf16 v[32:35], v[176:179], v[160:163], v[32:35]
    ds_read_b128 v[124:127], v207 offset:22528
    v_mfma_f32_16x16x32_bf16 v[60:63], v[176:179], v[164:167], v[60:63]
    ds_read_b64_tr_b16 v[132:133], v201 offset:32768
    v_mfma_f32_16x16x32_bf16 v[88:91], v[176:179], v[168:171], v[88:91]
    ds_read_b64_tr_b16 v[134:135], v201 offset:34816
    v_mfma_f32_16x16x32_bf16 v[8:11], v[180:183], v[156:159], v[8:11]
    ds_read_b64_tr_b16 v[136:137], v202 offset:32768
    v_mfma_f32_16x16x32_bf16 v[36:39], v[180:183], v[160:163], v[36:39]
    ds_read_b64_tr_b16 v[138:139], v202 offset:34816
    v_mfma_f32_16x16x32_bf16 v[64:67], v[180:183], v[164:167], v[64:67]
    ds_read_b64_tr_b16 v[140:141], v203 offset:32768
    v_mfma_f32_16x16x32_bf16 v[92:95], v[180:183], v[168:171], v[92:95]
    ds_read_b64_tr_b16 v[142:143], v203 offset:34816
    v_mfma_f32_16x16x32_bf16 v[12:15], v[184:187], v[156:159], v[12:15]
    ds_read_b64_tr_b16 v[144:145], v204 offset:32768
    v_mfma_f32_16x16x32_bf16 v[40:43], v[184:187], v[160:163], v[40:43]
    ds_read_b64_tr_b16 v[146:147], v204 offset:34816
    v_mfma_f32_16x16x32_bf16 v[68:71], v[184:187], v[164:167], v[68:71]
    ds_read_b64_tr_b16 v[148:149], v205 offset:32768
    v_mfma_f32_16x16x32_bf16 v[96:99], v[184:187], v[168:171], v[96:99]
    ds_read_b64_tr_b16 v[150:151], v205 offset:34816
    v_mfma_f32_16x16x32_bf16 v[16:19], v[188:191], v[156:159], v[16:19]
    ds_read_b64_tr_b16 v[152:153], v206 offset:32768
    v_mfma_f32_16x16x32_bf16 v[44:47], v[188:191], v[160:163], v[44:47]
    ds_read_b64_tr_b16 v[154:155], v206 offset:34816
    v_mfma_f32_16x16x32_bf16 v[72:75], v[188:191], v[164:167], v[72:75]
    v_mfma_f32_16x16x32_bf16 v[100:103], v[188:191], v[168:171], v[100:103]
    v_mfma_f32_16x16x32_bf16 v[20:23], v[192:195], v[156:159], v[20:23]
    v_mfma_f32_16x16x32_bf16 v[48:51], v[192:195], v[160:163], v[48:51]
    v_mfma_f32_16x16x32_bf16 v[76:79], v[192:195], v[164:167], v[76:79]
    v_mfma_f32_16x16x32_bf16 v[104:107], v[192:195], v[168:171], v[104:107]
    v_mfma_f32_16x16x32_bf16 v[24:27], v[196:199], v[156:159], v[24:27]
    v_mfma_f32_16x16x32_bf16 v[52:55], v[196:199], v[160:163], v[52:55]
    v_mfma_f32_16x16x32_bf16 v[80:83], v[196:199], v[164:167], v[80:83]
    v_mfma_f32_16x16x32_bf16 v[108:111], v[196:199], v[168:171], v[108:111]
    s_waitcnt lgkmcnt(0)
    v_mfma_f32_16x16x32_bf16 v[0:3], v[128:131], v[112:115], v[0:3]
    ds_read_b128 v[156:159], v222 offset:16384
    v_mfma_f32_16x16x32_bf16 v[28:31], v[128:131], v[116:119], v[28:31]
    ds_read_b128 v[160:163], v222 offset:18432
    v_mfma_f32_16x16x32_bf16 v[56:59], v[128:131], v[120:123], v[56:59]
    ds_read_b64_tr_b16 v[172:173], v200 offset:49152
    v_mfma_f32_16x16x32_bf16 v[84:87], v[128:131], v[124:127], v[84:87]
    ds_read_b64_tr_b16 v[174:175], v200 offset:51200
    v_mfma_f32_16x16x32_bf16 v[4:7], v[132:135], v[112:115], v[4:7]
    ds_read_b128 v[164:167], v222 offset:20480
    v_mfma_f32_16x16x32_bf16 v[32:35], v[132:135], v[116:119], v[32:35]
    ds_read_b128 v[168:171], v222 offset:22528
    v_mfma_f32_16x16x32_bf16 v[60:63], v[132:135], v[120:123], v[60:63]
    ds_read_b64_tr_b16 v[176:177], v201 offset:49152
    v_mfma_f32_16x16x32_bf16 v[88:91], v[132:135], v[124:127], v[88:91]
    ds_read_b64_tr_b16 v[178:179], v201 offset:51200
    v_mfma_f32_16x16x32_bf16 v[8:11], v[136:139], v[112:115], v[8:11]
    ds_read_b64_tr_b16 v[180:181], v202 offset:49152
    v_mfma_f32_16x16x32_bf16 v[36:39], v[136:139], v[116:119], v[36:39]
    ds_read_b64_tr_b16 v[182:183], v202 offset:51200
    v_mfma_f32_16x16x32_bf16 v[64:67], v[136:139], v[120:123], v[64:67]
    ds_read_b64_tr_b16 v[184:185], v203 offset:49152
    v_mfma_f32_16x16x32_bf16 v[92:95], v[136:139], v[124:127], v[92:95]
    ds_read_b64_tr_b16 v[186:187], v203 offset:51200
    v_mfma_f32_16x16x32_bf16 v[12:15], v[140:143], v[112:115], v[12:15]
    ds_read_b64_tr_b16 v[188:189], v204 offset:49152
    v_mfma_f32_16x16x32_bf16 v[40:43], v[140:143], v[116:119], v[40:43]
    ds_read_b64_tr_b16 v[190:191], v204 offset:51200
    v_mfma_f32_16x16x32_bf16 v[68:71], v[140:143], v[120:123], v[68:71]
    ds_read_b64_tr_b16 v[192:193], v205 offset:49152
    v_mfma_f32_16x16x32_bf16 v[96:99], v[140:143], v[124:127], v[96:99]
    ds_read_b64_tr_b16 v[194:195], v205 offset:51200
    v_mfma_f32_16x16x32_bf16 v[16:19], v[144:147], v[112:115], v[16:19]
    ds_read_b64_tr_b16 v[196:197], v206 offset:49152
    v_mfma_f32_16x16x32_bf16 v[44:47], v[144:147], v[116:119], v[44:47]
    ds_read_b64_tr_b16 v[198:199], v206 offset:51200
    v_mfma_f32_16x16x32_bf16 v[72:75], v[144:147], v[120:123], v[72:75]
    v_mfma_f32_16x16x32_bf16 v[100:103], v[144:147], v[124:127], v[100:103]
    v_mfma_f32_16x16x32_bf16 v[20:23], v[148:151], v[112:115], v[20:23]
    v_mfma_f32_16x16x32_bf16 v[48:51], v[148:151], v[116:119], v[48:51]
    v_mfma_f32_16x16x32_bf16 v[76:79], v[148:151], v[120:123], v[76:79]
    v_mfma_f32_16x16x32_bf16 v[104:107], v[148:151], v[124:127], v[104:107]
    v_mfma_f32_16x16x32_bf16 v[24:27], v[152:155], v[112:115], v[24:27]
    v_mfma_f32_16x16x32_bf16 v[52:55], v[152:155], v[116:119], v[52:55]
    v_mfma_f32_16x16x32_bf16 v[80:83], v[152:155], v[120:123], v[80:83]
    v_mfma_f32_16x16x32_bf16 v[108:111], v[152:155], v[124:127], v[108:111]
    s_waitcnt lgkmcnt(0)
    s_barrier
    s_mov_b32 s53, 1769472
    buffer_load_dword v214, v213, s[16:19], s53 offen
    v_mfma_f32_16x16x32_bf16 v[0:3], v[172:175], v[156:159], v[0:3]
    ds_read_b128 v[112:115], v207 offset:32768
    v_mfma_f32_16x16x32_bf16 v[28:31], v[172:175], v[160:163], v[28:31]
    ds_read_b128 v[116:119], v207 offset:34816
    v_mfma_f32_16x16x32_bf16 v[56:59], v[172:175], v[164:167], v[56:59]
    ds_read_b64_tr_b16 v[128:129], v215 offset:0
    v_mfma_f32_16x16x32_bf16 v[84:87], v[172:175], v[168:171], v[84:87]
    ds_read_b64_tr_b16 v[130:131], v215 offset:2048
    v_mfma_f32_16x16x32_bf16 v[4:7], v[176:179], v[156:159], v[4:7]
    ds_read_b128 v[120:123], v207 offset:36864
    v_mfma_f32_16x16x32_bf16 v[32:35], v[176:179], v[160:163], v[32:35]
    ds_read_b128 v[124:127], v207 offset:38912
    v_mfma_f32_16x16x32_bf16 v[60:63], v[176:179], v[164:167], v[60:63]
    ds_read_b64_tr_b16 v[132:133], v216 offset:0
    v_mfma_f32_16x16x32_bf16 v[88:91], v[176:179], v[168:171], v[88:91]
    ds_read_b64_tr_b16 v[134:135], v216 offset:2048
    v_mfma_f32_16x16x32_bf16 v[8:11], v[180:183], v[156:159], v[8:11]
    ds_read_b64_tr_b16 v[136:137], v217 offset:0
    v_mfma_f32_16x16x32_bf16 v[36:39], v[180:183], v[160:163], v[36:39]
    ds_read_b64_tr_b16 v[138:139], v217 offset:2048
    v_mfma_f32_16x16x32_bf16 v[64:67], v[180:183], v[164:167], v[64:67]
    ds_read_b64_tr_b16 v[140:141], v218 offset:0
    v_mfma_f32_16x16x32_bf16 v[92:95], v[180:183], v[168:171], v[92:95]
    ds_read_b64_tr_b16 v[142:143], v218 offset:2048
    v_mfma_f32_16x16x32_bf16 v[12:15], v[184:187], v[156:159], v[12:15]
    ds_read_b64_tr_b16 v[144:145], v219 offset:0
    v_mfma_f32_16x16x32_bf16 v[40:43], v[184:187], v[160:163], v[40:43]
    ds_read_b64_tr_b16 v[146:147], v219 offset:2048
    v_mfma_f32_16x16x32_bf16 v[68:71], v[184:187], v[164:167], v[68:71]
    ds_read_b64_tr_b16 v[148:149], v220 offset:0
    v_mfma_f32_16x16x32_bf16 v[96:99], v[184:187], v[168:171], v[96:99]
    ds_read_b64_tr_b16 v[150:151], v220 offset:2048
    v_mfma_f32_16x16x32_bf16 v[16:19], v[188:191], v[156:159], v[16:19]
    ds_read_b64_tr_b16 v[152:153], v221 offset:0
    v_mfma_f32_16x16x32_bf16 v[44:47], v[188:191], v[160:163], v[44:47]
    ds_read_b64_tr_b16 v[154:155], v221 offset:2048
    v_mfma_f32_16x16x32_bf16 v[72:75], v[188:191], v[164:167], v[72:75]
    v_mfma_f32_16x16x32_bf16 v[100:103], v[188:191], v[168:171], v[100:103]
    v_mfma_f32_16x16x32_bf16 v[20:23], v[192:195], v[156:159], v[20:23]
    v_mfma_f32_16x16x32_bf16 v[48:51], v[192:195], v[160:163], v[48:51]
    v_mfma_f32_16x16x32_bf16 v[76:79], v[192:195], v[164:167], v[76:79]
    v_mfma_f32_16x16x32_bf16 v[104:107], v[192:195], v[168:171], v[104:107]
    v_mfma_f32_16x16x32_bf16 v[24:27], v[196:199], v[156:159], v[24:27]
    v_mfma_f32_16x16x32_bf16 v[52:55], v[196:199], v[160:163], v[52:55]
    v_mfma_f32_16x16x32_bf16 v[80:83], v[196:199], v[164:167], v[80:83]
    v_mfma_f32_16x16x32_bf16 v[108:111], v[196:199], v[168:171], v[108:111]
    s_waitcnt lgkmcnt(0)
    v_mfma_f32_16x16x32_bf16 v[0:3], v[128:131], v[112:115], v[0:3]
    ds_read_b128 v[156:159], v222 offset:32768
    v_mfma_f32_16x16x32_bf16 v[28:31], v[128:131], v[116:119], v[28:31]
    ds_read_b128 v[160:163], v222 offset:34816
    v_mfma_f32_16x16x32_bf16 v[56:59], v[128:131], v[120:123], v[56:59]
    ds_read_b64_tr_b16 v[172:173], v215 offset:16384
    v_mfma_f32_16x16x32_bf16 v[84:87], v[128:131], v[124:127], v[84:87]
    ds_read_b64_tr_b16 v[174:175], v215 offset:18432
    v_mfma_f32_16x16x32_bf16 v[4:7], v[132:135], v[112:115], v[4:7]
    ds_read_b128 v[164:167], v222 offset:36864
    v_mfma_f32_16x16x32_bf16 v[32:35], v[132:135], v[116:119], v[32:35]
    ds_read_b128 v[168:171], v222 offset:38912
    v_mfma_f32_16x16x32_bf16 v[60:63], v[132:135], v[120:123], v[60:63]
    ds_read_b64_tr_b16 v[176:177], v216 offset:16384
    v_mfma_f32_16x16x32_bf16 v[88:91], v[132:135], v[124:127], v[88:91]
    ds_read_b64_tr_b16 v[178:179], v216 offset:18432
    v_mfma_f32_16x16x32_bf16 v[8:11], v[136:139], v[112:115], v[8:11]
    ds_read_b64_tr_b16 v[180:181], v217 offset:16384
    v_mfma_f32_16x16x32_bf16 v[36:39], v[136:139], v[116:119], v[36:39]
    ds_read_b64_tr_b16 v[182:183], v217 offset:18432
    v_mfma_f32_16x16x32_bf16 v[64:67], v[136:139], v[120:123], v[64:67]
    ds_read_b64_tr_b16 v[184:185], v218 offset:16384
    v_mfma_f32_16x16x32_bf16 v[92:95], v[136:139], v[124:127], v[92:95]
    ds_read_b64_tr_b16 v[186:187], v218 offset:18432
    v_mfma_f32_16x16x32_bf16 v[12:15], v[140:143], v[112:115], v[12:15]
    ds_read_b64_tr_b16 v[188:189], v219 offset:16384
    v_mfma_f32_16x16x32_bf16 v[40:43], v[140:143], v[116:119], v[40:43]
    ds_read_b64_tr_b16 v[190:191], v219 offset:18432
    v_mfma_f32_16x16x32_bf16 v[68:71], v[140:143], v[120:123], v[68:71]
    ds_read_b64_tr_b16 v[192:193], v220 offset:16384
    v_mfma_f32_16x16x32_bf16 v[96:99], v[140:143], v[124:127], v[96:99]
    ds_read_b64_tr_b16 v[194:195], v220 offset:18432
    v_mfma_f32_16x16x32_bf16 v[16:19], v[144:147], v[112:115], v[16:19]
    ds_read_b64_tr_b16 v[196:197], v221 offset:16384
    v_mfma_f32_16x16x32_bf16 v[44:47], v[144:147], v[116:119], v[44:47]
    ds_read_b64_tr_b16 v[198:199], v221 offset:18432
    v_mfma_f32_16x16x32_bf16 v[72:75], v[144:147], v[120:123], v[72:75]
    v_mfma_f32_16x16x32_bf16 v[100:103], v[144:147], v[124:127], v[100:103]
    v_mfma_f32_16x16x32_bf16 v[20:23], v[148:151], v[112:115], v[20:23]
    v_mfma_f32_16x16x32_bf16 v[48:51], v[148:151], v[116:119], v[48:51]
    v_mfma_f32_16x16x32_bf16 v[76:79], v[148:151], v[120:123], v[76:79]
    v_mfma_f32_16x16x32_bf16 v[104:107], v[148:151], v[124:127], v[104:107]
    v_mfma_f32_16x16x32_bf16 v[24:27], v[152:155], v[112:115], v[24:27]
    v_mfma_f32_16x16x32_bf16 v[52:55], v[152:155], v[116:119], v[52:55]
    v_mfma_f32_16x16x32_bf16 v[80:83], v[152:155], v[120:123], v[80:83]
    v_mfma_f32_16x16x32_bf16 v[108:111], v[152:155], v[124:127], v[108:111]
    s_waitcnt lgkmcnt(0)
    s_barrier
    v_mfma_f32_16x16x32_bf16 v[0:3], v[172:175], v[156:159], v[0:3]
    ds_read_b128 v[112:115], v207 offset:0
    v_mfma_f32_16x16x32_bf16 v[28:31], v[172:175], v[160:163], v[28:31]
    ds_read_b128 v[116:119], v207 offset:2048
    v_mfma_f32_16x16x32_bf16 v[56:59], v[172:175], v[164:167], v[56:59]
    ds_read_b64_tr_b16 v[128:129], v200 offset:0
    v_mfma_f32_16x16x32_bf16 v[84:87], v[172:175], v[168:171], v[84:87]
    ds_read_b64_tr_b16 v[130:131], v200 offset:2048
    v_mfma_f32_16x16x32_bf16 v[4:7], v[176:179], v[156:159], v[4:7]
    ds_read_b128 v[120:123], v207 offset:4096
    v_mfma_f32_16x16x32_bf16 v[32:35], v[176:179], v[160:163], v[32:35]
    ds_read_b128 v[124:127], v207 offset:6144
    v_mfma_f32_16x16x32_bf16 v[60:63], v[176:179], v[164:167], v[60:63]
    ds_read_b64_tr_b16 v[132:133], v201 offset:0
    v_mfma_f32_16x16x32_bf16 v[88:91], v[176:179], v[168:171], v[88:91]
    ds_read_b64_tr_b16 v[134:135], v201 offset:2048
    v_mfma_f32_16x16x32_bf16 v[8:11], v[180:183], v[156:159], v[8:11]
    ds_read_b64_tr_b16 v[136:137], v202 offset:0
    v_mfma_f32_16x16x32_bf16 v[36:39], v[180:183], v[160:163], v[36:39]
    ds_read_b64_tr_b16 v[138:139], v202 offset:2048
    v_mfma_f32_16x16x32_bf16 v[64:67], v[180:183], v[164:167], v[64:67]
    ds_read_b64_tr_b16 v[140:141], v203 offset:0
    v_mfma_f32_16x16x32_bf16 v[92:95], v[180:183], v[168:171], v[92:95]
    ds_read_b64_tr_b16 v[142:143], v203 offset:2048
    v_mfma_f32_16x16x32_bf16 v[12:15], v[184:187], v[156:159], v[12:15]
    ds_read_b64_tr_b16 v[144:145], v204 offset:0
    v_mfma_f32_16x16x32_bf16 v[40:43], v[184:187], v[160:163], v[40:43]
    ds_read_b64_tr_b16 v[146:147], v204 offset:2048
    v_mfma_f32_16x16x32_bf16 v[68:71], v[184:187], v[164:167], v[68:71]
    ds_read_b64_tr_b16 v[148:149], v205 offset:0
    v_mfma_f32_16x16x32_bf16 v[96:99], v[184:187], v[168:171], v[96:99]
    ds_read_b64_tr_b16 v[150:151], v205 offset:2048
    v_mfma_f32_16x16x32_bf16 v[16:19], v[188:191], v[156:159], v[16:19]
    ds_read_b64_tr_b16 v[152:153], v206 offset:0
    v_mfma_f32_16x16x32_bf16 v[44:47], v[188:191], v[160:163], v[44:47]
    ds_read_b64_tr_b16 v[154:155], v206 offset:2048
    v_mfma_f32_16x16x32_bf16 v[72:75], v[188:191], v[164:167], v[72:75]
    v_mfma_f32_16x16x32_bf16 v[100:103], v[188:191], v[168:171], v[100:103]
    v_mfma_f32_16x16x32_bf16 v[20:23], v[192:195], v[156:159], v[20:23]
    v_mfma_f32_16x16x32_bf16 v[48:51], v[192:195], v[160:163], v[48:51]
    v_mfma_f32_16x16x32_bf16 v[76:79], v[192:195], v[164:167], v[76:79]
    v_mfma_f32_16x16x32_bf16 v[104:107], v[192:195], v[168:171], v[104:107]
    v_mfma_f32_16x16x32_bf16 v[24:27], v[196:199], v[156:159], v[24:27]
    v_mfma_f32_16x16x32_bf16 v[52:55], v[196:199], v[160:163], v[52:55]
    v_mfma_f32_16x16x32_bf16 v[80:83], v[196:199], v[164:167], v[80:83]
    v_mfma_f32_16x16x32_bf16 v[108:111], v[196:199], v[168:171], v[108:111]
    s_waitcnt lgkmcnt(0)
    v_mfma_f32_16x16x32_bf16 v[0:3], v[128:131], v[112:115], v[0:3]
    ds_read_b128 v[156:159], v222 offset:0
    v_mfma_f32_16x16x32_bf16 v[28:31], v[128:131], v[116:119], v[28:31]
    ds_read_b128 v[160:163], v222 offset:2048
    v_mfma_f32_16x16x32_bf16 v[56:59], v[128:131], v[120:123], v[56:59]
    ds_read_b64_tr_b16 v[172:173], v200 offset:16384
    v_mfma_f32_16x16x32_bf16 v[84:87], v[128:131], v[124:127], v[84:87]
    ds_read_b64_tr_b16 v[174:175], v200 offset:18432
    v_mfma_f32_16x16x32_bf16 v[4:7], v[132:135], v[112:115], v[4:7]
    ds_read_b128 v[164:167], v222 offset:4096
    v_mfma_f32_16x16x32_bf16 v[32:35], v[132:135], v[116:119], v[32:35]
    ds_read_b128 v[168:171], v222 offset:6144
    v_mfma_f32_16x16x32_bf16 v[60:63], v[132:135], v[120:123], v[60:63]
    ds_read_b64_tr_b16 v[176:177], v201 offset:16384
    v_mfma_f32_16x16x32_bf16 v[88:91], v[132:135], v[124:127], v[88:91]
    ds_read_b64_tr_b16 v[178:179], v201 offset:18432
    v_mfma_f32_16x16x32_bf16 v[8:11], v[136:139], v[112:115], v[8:11]
    ds_read_b64_tr_b16 v[180:181], v202 offset:16384
    v_mfma_f32_16x16x32_bf16 v[36:39], v[136:139], v[116:119], v[36:39]
    ds_read_b64_tr_b16 v[182:183], v202 offset:18432
    v_mfma_f32_16x16x32_bf16 v[64:67], v[136:139], v[120:123], v[64:67]
    ds_read_b64_tr_b16 v[184:185], v203 offset:16384
    v_mfma_f32_16x16x32_bf16 v[92:95], v[136:139], v[124:127], v[92:95]
    ds_read_b64_tr_b16 v[186:187], v203 offset:18432
    v_mfma_f32_16x16x32_bf16 v[12:15], v[140:143], v[112:115], v[12:15]
    ds_read_b64_tr_b16 v[188:189], v204 offset:16384
    v_mfma_f32_16x16x32_bf16 v[40:43], v[140:143], v[116:119], v[40:43]
    ds_read_b64_tr_b16 v[190:191], v204 offset:18432
    v_mfma_f32_16x16x32_bf16 v[68:71], v[140:143], v[120:123], v[68:71]
    ds_read_b64_tr_b16 v[192:193], v205 offset:16384
    v_mfma_f32_16x16x32_bf16 v[96:99], v[140:143], v[124:127], v[96:99]
    ds_read_b64_tr_b16 v[194:195], v205 offset:18432
    v_mfma_f32_16x16x32_bf16 v[16:19], v[144:147], v[112:115], v[16:19]
    ds_read_b64_tr_b16 v[196:197], v206 offset:16384
    v_mfma_f32_16x16x32_bf16 v[44:47], v[144:147], v[116:119], v[44:47]
    ds_read_b64_tr_b16 v[198:199], v206 offset:18432
    v_mfma_f32_16x16x32_bf16 v[72:75], v[144:147], v[120:123], v[72:75]
    v_mfma_f32_16x16x32_bf16 v[100:103], v[144:147], v[124:127], v[100:103]
    v_mfma_f32_16x16x32_bf16 v[20:23], v[148:151], v[112:115], v[20:23]
    v_mfma_f32_16x16x32_bf16 v[48:51], v[148:151], v[116:119], v[48:51]
    v_mfma_f32_16x16x32_bf16 v[76:79], v[148:151], v[120:123], v[76:79]
    v_mfma_f32_16x16x32_bf16 v[104:107], v[148:151], v[124:127], v[104:107]
    v_mfma_f32_16x16x32_bf16 v[24:27], v[152:155], v[112:115], v[24:27]
    v_mfma_f32_16x16x32_bf16 v[52:55], v[152:155], v[116:119], v[52:55]
    v_mfma_f32_16x16x32_bf16 v[80:83], v[152:155], v[120:123], v[80:83]
    v_mfma_f32_16x16x32_bf16 v[108:111], v[152:155], v[124:127], v[108:111]
    s_waitcnt lgkmcnt(0)
    s_barrier
    v_mfma_f32_16x16x32_bf16 v[0:3], v[172:175], v[156:159], v[0:3]
    ds_read_b128 v[112:115], v207 offset:16384
    v_mfma_f32_16x16x32_bf16 v[28:31], v[172:175], v[160:163], v[28:31]
    ds_read_b128 v[116:119], v207 offset:18432
    v_mfma_f32_16x16x32_bf16 v[56:59], v[172:175], v[164:167], v[56:59]
    ds_read_b64_tr_b16 v[128:129], v200 offset:32768
    v_mfma_f32_16x16x32_bf16 v[84:87], v[172:175], v[168:171], v[84:87]
    ds_read_b64_tr_b16 v[130:131], v200 offset:34816
    v_mfma_f32_16x16x32_bf16 v[4:7], v[176:179], v[156:159], v[4:7]
    ds_read_b128 v[120:123], v207 offset:20480
    v_mfma_f32_16x16x32_bf16 v[32:35], v[176:179], v[160:163], v[32:35]
    ds_read_b128 v[124:127], v207 offset:22528
    v_mfma_f32_16x16x32_bf16 v[60:63], v[176:179], v[164:167], v[60:63]
    ds_read_b64_tr_b16 v[132:133], v201 offset:32768
    v_mfma_f32_16x16x32_bf16 v[88:91], v[176:179], v[168:171], v[88:91]
    ds_read_b64_tr_b16 v[134:135], v201 offset:34816
    v_mfma_f32_16x16x32_bf16 v[8:11], v[180:183], v[156:159], v[8:11]
    ds_read_b64_tr_b16 v[136:137], v202 offset:32768
    v_mfma_f32_16x16x32_bf16 v[36:39], v[180:183], v[160:163], v[36:39]
    ds_read_b64_tr_b16 v[138:139], v202 offset:34816
    v_mfma_f32_16x16x32_bf16 v[64:67], v[180:183], v[164:167], v[64:67]
    ds_read_b64_tr_b16 v[140:141], v203 offset:32768
    v_mfma_f32_16x16x32_bf16 v[92:95], v[180:183], v[168:171], v[92:95]
    ds_read_b64_tr_b16 v[142:143], v203 offset:34816
    v_mfma_f32_16x16x32_bf16 v[12:15], v[184:187], v[156:159], v[12:15]
    ds_read_b64_tr_b16 v[144:145], v204 offset:32768
    v_mfma_f32_16x16x32_bf16 v[40:43], v[184:187], v[160:163], v[40:43]
    ds_read_b64_tr_b16 v[146:147], v204 offset:34816
    v_mfma_f32_16x16x32_bf16 v[68:71], v[184:187], v[164:167], v[68:71]
    ds_read_b64_tr_b16 v[148:149], v205 offset:32768
    v_mfma_f32_16x16x32_bf16 v[96:99], v[184:187], v[168:171], v[96:99]
    ds_read_b64_tr_b16 v[150:151], v205 offset:34816
    v_mfma_f32_16x16x32_bf16 v[16:19], v[188:191], v[156:159], v[16:19]
    ds_read_b64_tr_b16 v[152:153], v206 offset:32768
    v_mfma_f32_16x16x32_bf16 v[44:47], v[188:191], v[160:163], v[44:47]
    ds_read_b64_tr_b16 v[154:155], v206 offset:34816
    v_mfma_f32_16x16x32_bf16 v[72:75], v[188:191], v[164:167], v[72:75]
    v_mfma_f32_16x16x32_bf16 v[100:103], v[188:191], v[168:171], v[100:103]
    v_mfma_f32_16x16x32_bf16 v[20:23], v[192:195], v[156:159], v[20:23]
    v_mfma_f32_16x16x32_bf16 v[48:51], v[192:195], v[160:163], v[48:51]
    v_mfma_f32_16x16x32_bf16 v[76:79], v[192:195], v[164:167], v[76:79]
    v_mfma_f32_16x16x32_bf16 v[104:107], v[192:195], v[168:171], v[104:107]
    v_mfma_f32_16x16x32_bf16 v[24:27], v[196:199], v[156:159], v[24:27]
    v_mfma_f32_16x16x32_bf16 v[52:55], v[196:199], v[160:163], v[52:55]
    v_mfma_f32_16x16x32_bf16 v[80:83], v[196:199], v[164:167], v[80:83]
    v_mfma_f32_16x16x32_bf16 v[108:111], v[196:199], v[168:171], v[108:111]
    s_waitcnt lgkmcnt(0)
    v_mfma_f32_16x16x32_bf16 v[0:3], v[128:131], v[112:115], v[0:3]
    ds_read_b128 v[156:159], v222 offset:16384
    v_mfma_f32_16x16x32_bf16 v[28:31], v[128:131], v[116:119], v[28:31]
    ds_read_b128 v[160:163], v222 offset:18432
    v_mfma_f32_16x16x32_bf16 v[56:59], v[128:131], v[120:123], v[56:59]
    ds_read_b64_tr_b16 v[172:173], v200 offset:49152
    v_mfma_f32_16x16x32_bf16 v[84:87], v[128:131], v[124:127], v[84:87]
    ds_read_b64_tr_b16 v[174:175], v200 offset:51200
    v_mfma_f32_16x16x32_bf16 v[4:7], v[132:135], v[112:115], v[4:7]
    ds_read_b128 v[164:167], v222 offset:20480
    v_mfma_f32_16x16x32_bf16 v[32:35], v[132:135], v[116:119], v[32:35]
    ds_read_b128 v[168:171], v222 offset:22528
    v_mfma_f32_16x16x32_bf16 v[60:63], v[132:135], v[120:123], v[60:63]
    ds_read_b64_tr_b16 v[176:177], v201 offset:49152
    v_mfma_f32_16x16x32_bf16 v[88:91], v[132:135], v[124:127], v[88:91]
    ds_read_b64_tr_b16 v[178:179], v201 offset:51200
    v_mfma_f32_16x16x32_bf16 v[8:11], v[136:139], v[112:115], v[8:11]
    ds_read_b64_tr_b16 v[180:181], v202 offset:49152
    v_mfma_f32_16x16x32_bf16 v[36:39], v[136:139], v[116:119], v[36:39]
    ds_read_b64_tr_b16 v[182:183], v202 offset:51200
    v_mfma_f32_16x16x32_bf16 v[64:67], v[136:139], v[120:123], v[64:67]
    ds_read_b64_tr_b16 v[184:185], v203 offset:49152
    v_mfma_f32_16x16x32_bf16 v[92:95], v[136:139], v[124:127], v[92:95]
    ds_read_b64_tr_b16 v[186:187], v203 offset:51200
    v_mfma_f32_16x16x32_bf16 v[12:15], v[140:143], v[112:115], v[12:15]
    ds_read_b64_tr_b16 v[188:189], v204 offset:49152
    v_mfma_f32_16x16x32_bf16 v[40:43], v[140:143], v[116:119], v[40:43]
    ds_read_b64_tr_b16 v[190:191], v204 offset:51200
    v_mfma_f32_16x16x32_bf16 v[68:71], v[140:143], v[120:123], v[68:71]
    ds_read_b64_tr_b16 v[192:193], v205 offset:49152
    v_mfma_f32_16x16x32_bf16 v[96:99], v[140:143], v[124:127], v[96:99]
    ds_read_b64_tr_b16 v[194:195], v205 offset:51200
    v_mfma_f32_16x16x32_bf16 v[16:19], v[144:147], v[112:115], v[16:19]
    ds_read_b64_tr_b16 v[196:197], v206 offset:49152
    v_mfma_f32_16x16x32_bf16 v[44:47], v[144:147], v[116:119], v[44:47]
    ds_read_b64_tr_b16 v[198:199], v206 offset:51200
    v_mfma_f32_16x16x32_bf16 v[72:75], v[144:147], v[120:123], v[72:75]
    v_mfma_f32_16x16x32_bf16 v[100:103], v[144:147], v[124:127], v[100:103]
    v_mfma_f32_16x16x32_bf16 v[20:23], v[148:151], v[112:115], v[20:23]
    v_mfma_f32_16x16x32_bf16 v[48:51], v[148:151], v[116:119], v[48:51]
    v_mfma_f32_16x16x32_bf16 v[76:79], v[148:151], v[120:123], v[76:79]
    v_mfma_f32_16x16x32_bf16 v[104:107], v[148:151], v[124:127], v[104:107]
    v_mfma_f32_16x16x32_bf16 v[24:27], v[152:155], v[112:115], v[24:27]
    v_mfma_f32_16x16x32_bf16 v[52:55], v[152:155], v[116:119], v[52:55]
    v_mfma_f32_16x16x32_bf16 v[80:83], v[152:155], v[120:123], v[80:83]
    v_mfma_f32_16x16x32_bf16 v[108:111], v[152:155], v[124:127], v[108:111]
    s_waitcnt lgkmcnt(0)
    v_mfma_f32_16x16x32_bf16 v[0:3], v[172:175], v[156:159], v[0:3]
    v_mfma_f32_16x16x32_bf16 v[28:31], v[172:175], v[160:163], v[28:31]
    v_mfma_f32_16x16x32_bf16 v[56:59], v[172:175], v[164:167], v[56:59]
    v_mfma_f32_16x16x32_bf16 v[84:87], v[172:175], v[168:171], v[84:87]
    v_mfma_f32_16x16x32_bf16 v[4:7], v[176:179], v[156:159], v[4:7]
    v_mfma_f32_16x16x32_bf16 v[32:35], v[176:179], v[160:163], v[32:35]
    v_mfma_f32_16x16x32_bf16 v[60:63], v[176:179], v[164:167], v[60:63]
    v_mfma_f32_16x16x32_bf16 v[88:91], v[176:179], v[168:171], v[88:91]
    v_mfma_f32_16x16x32_bf16 v[8:11], v[180:183], v[156:159], v[8:11]
    v_mfma_f32_16x16x32_bf16 v[36:39], v[180:183], v[160:163], v[36:39]
    v_mfma_f32_16x16x32_bf16 v[64:67], v[180:183], v[164:167], v[64:67]
    v_mfma_f32_16x16x32_bf16 v[92:95], v[180:183], v[168:171], v[92:95]
    v_mfma_f32_16x16x32_bf16 v[12:15], v[184:187], v[156:159], v[12:15]
    v_mfma_f32_16x16x32_bf16 v[40:43], v[184:187], v[160:163], v[40:43]
    s_barrier
    v_mfma_f32_16x16x32_bf16 v[68:71], v[184:187], v[164:167], v[68:71]
    ds_read_b128 v[112:115], v207 offset:32768
    v_mfma_f32_16x16x32_bf16 v[96:99], v[184:187], v[168:171], v[96:99]
    ds_read_b128 v[116:119], v207 offset:34816
    v_mfma_f32_16x16x32_bf16 v[16:19], v[188:191], v[156:159], v[16:19]
    ds_read_b64_tr_b16 v[128:129], v215 offset:0
    v_mfma_f32_16x16x32_bf16 v[44:47], v[188:191], v[160:163], v[44:47]
    ds_read_b64_tr_b16 v[130:131], v215 offset:2048
    v_mfma_f32_16x16x32_bf16 v[72:75], v[188:191], v[164:167], v[72:75]
    ds_read_b128 v[120:123], v207 offset:36864
    v_mfma_f32_16x16x32_bf16 v[100:103], v[188:191], v[168:171], v[100:103]
    ds_read_b128 v[124:127], v207 offset:38912
    v_mfma_f32_16x16x32_bf16 v[20:23], v[192:195], v[156:159], v[20:23]
    ds_read_b64_tr_b16 v[132:133], v216 offset:0
    v_mfma_f32_16x16x32_bf16 v[48:51], v[192:195], v[160:163], v[48:51]
    ds_read_b64_tr_b16 v[134:135], v216 offset:2048
    v_mfma_f32_16x16x32_bf16 v[76:79], v[192:195], v[164:167], v[76:79]
    ds_read_b64_tr_b16 v[136:137], v217 offset:0
    v_mfma_f32_16x16x32_bf16 v[104:107], v[192:195], v[168:171], v[104:107]
    ds_read_b64_tr_b16 v[138:139], v217 offset:2048
    v_mfma_f32_16x16x32_bf16 v[24:27], v[196:199], v[156:159], v[24:27]
    ds_read_b64_tr_b16 v[140:141], v218 offset:0
    v_mfma_f32_16x16x32_bf16 v[52:55], v[196:199], v[160:163], v[52:55]
    ds_read_b64_tr_b16 v[142:143], v218 offset:2048
    v_mfma_f32_16x16x32_bf16 v[80:83], v[196:199], v[164:167], v[80:83]
    ds_read_b64_tr_b16 v[144:145], v219 offset:0
    v_mfma_f32_16x16x32_bf16 v[108:111], v[196:199], v[168:171], v[108:111]
    ds_read_b64_tr_b16 v[146:147], v219 offset:2048
    ds_read_b64_tr_b16 v[148:149], v220 offset:0
    ds_read_b64_tr_b16 v[150:151], v220 offset:2048
    ds_read_b64_tr_b16 v[152:153], v221 offset:0
    ds_read_b64_tr_b16 v[154:155], v221 offset:2048
    s_waitcnt lgkmcnt(0)
    v_mfma_f32_16x16x32_bf16 v[0:3], v[128:131], v[112:115], v[0:3]
    v_mfma_f32_16x16x32_bf16 v[28:31], v[128:131], v[116:119], v[28:31]
    v_mfma_f32_16x16x32_bf16 v[56:59], v[128:131], v[120:123], v[56:59]
    v_mfma_f32_16x16x32_bf16 v[84:87], v[128:131], v[124:127], v[84:87]
    v_mfma_f32_16x16x32_bf16 v[4:7], v[132:135], v[112:115], v[4:7]
    v_mfma_f32_16x16x32_bf16 v[32:35], v[132:135], v[116:119], v[32:35]
    v_mfma_f32_16x16x32_bf16 v[60:63], v[132:135], v[120:123], v[60:63]
    v_mfma_f32_16x16x32_bf16 v[88:91], v[132:135], v[124:127], v[88:91]
    v_mfma_f32_16x16x32_bf16 v[8:11], v[136:139], v[112:115], v[8:11]
    v_mfma_f32_16x16x32_bf16 v[36:39], v[136:139], v[116:119], v[36:39]
    s_barrier
    v_mfma_f32_16x16x32_bf16 v[64:67], v[136:139], v[120:123], v[64:67]
    ds_read_b128 v[156:159], v222 offset:32768
    v_mfma_f32_16x16x32_bf16 v[92:95], v[136:139], v[124:127], v[92:95]
    ds_read_b128 v[160:163], v222 offset:34816
    v_mfma_f32_16x16x32_bf16 v[12:15], v[140:143], v[112:115], v[12:15]
    ds_read_b64_tr_b16 v[172:173], v215 offset:16384
    v_mfma_f32_16x16x32_bf16 v[40:43], v[140:143], v[116:119], v[40:43]
    ds_read_b64_tr_b16 v[174:175], v215 offset:18432
    v_mfma_f32_16x16x32_bf16 v[68:71], v[140:143], v[120:123], v[68:71]
    ds_read_b128 v[164:167], v222 offset:36864
    v_mfma_f32_16x16x32_bf16 v[96:99], v[140:143], v[124:127], v[96:99]
    ds_read_b128 v[168:171], v222 offset:38912
    v_mfma_f32_16x16x32_bf16 v[16:19], v[144:147], v[112:115], v[16:19]
    ds_read_b64_tr_b16 v[176:177], v216 offset:16384
    v_mfma_f32_16x16x32_bf16 v[44:47], v[144:147], v[116:119], v[44:47]
    ds_read_b64_tr_b16 v[178:179], v216 offset:18432
    v_mfma_f32_16x16x32_bf16 v[72:75], v[144:147], v[120:123], v[72:75]
    ds_read_b64_tr_b16 v[180:181], v217 offset:16384
    v_mfma_f32_16x16x32_bf16 v[100:103], v[144:147], v[124:127], v[100:103]
    ds_read_b64_tr_b16 v[182:183], v217 offset:18432
    v_mfma_f32_16x16x32_bf16 v[20:23], v[148:151], v[112:115], v[20:23]
    ds_read_b64_tr_b16 v[184:185], v218 offset:16384
    v_mfma_f32_16x16x32_bf16 v[48:51], v[148:151], v[116:119], v[48:51]
    ds_read_b64_tr_b16 v[186:187], v218 offset:18432
    v_mfma_f32_16x16x32_bf16 v[76:79], v[148:151], v[120:123], v[76:79]
    ds_read_b64_tr_b16 v[188:189], v219 offset:16384
    v_mfma_f32_16x16x32_bf16 v[104:107], v[148:151], v[124:127], v[104:107]
    ds_read_b64_tr_b16 v[190:191], v219 offset:18432
    v_mfma_f32_16x16x32_bf16 v[24:27], v[152:155], v[112:115], v[24:27]
    ds_read_b64_tr_b16 v[192:193], v220 offset:16384
    v_mfma_f32_16x16x32_bf16 v[52:55], v[152:155], v[116:119], v[52:55]
    ds_read_b64_tr_b16 v[194:195], v220 offset:18432
    v_mfma_f32_16x16x32_bf16 v[80:83], v[152:155], v[120:123], v[80:83]
    ds_read_b64_tr_b16 v[196:197], v221 offset:16384
    v_mfma_f32_16x16x32_bf16 v[108:111], v[152:155], v[124:127], v[108:111]
    ds_read_b64_tr_b16 v[198:199], v221 offset:18432
    s_waitcnt lgkmcnt(0)
    v_mfma_f32_16x16x32_bf16 v[0:3], v[172:175], v[156:159], v[0:3]
    v_mfma_f32_16x16x32_bf16 v[28:31], v[172:175], v[160:163], v[28:31]
    v_mfma_f32_16x16x32_bf16 v[56:59], v[172:175], v[164:167], v[56:59]
    v_mfma_f32_16x16x32_bf16 v[84:87], v[172:175], v[168:171], v[84:87]
    v_mfma_f32_16x16x32_bf16 v[4:7], v[176:179], v[156:159], v[4:7]
    v_mfma_f32_16x16x32_bf16 v[32:35], v[176:179], v[160:163], v[32:35]
    v_mfma_f32_16x16x32_bf16 v[60:63], v[176:179], v[164:167], v[60:63]
    v_mfma_f32_16x16x32_bf16 v[88:91], v[176:179], v[168:171], v[88:91]
    s_add_u32 s52, s54, 0
    s_lshr_b32 s53, s52, 3
    s_and_b32 s52, s52, 7
    s_add_u32 s52, s52, s56
    s_mul_i32 s52, s52, 229376
    s_cmp_eq_u32 s53, 0
    s_cselect_b32 s59, s57, s58
    s_add_u32 s60, s52, s59
    s_cmp_eq_u32 s53, 2
    s_cbranch_scc1 .Lqkv_ep_v0
    s_cmp_eq_u32 s53, 0
    s_cbranch_scc0 .Lqkv_ep_k0
    s_mov_b32 s59, 0x3eae1a93
    v_mfma_f32_16x16x32_bf16 v[8:11], v[180:183], v[156:159], v[8:11]
    v_mul_f32 v0, s59, v0
    v_mul_f32 v1, s59, v1
    v_mfma_f32_16x16x32_bf16 v[36:39], v[180:183], v[160:163], v[36:39]
    v_mul_f32 v2, s59, v2
    v_mul_f32 v3, s59, v3
    v_mfma_f32_16x16x32_bf16 v[64:67], v[180:183], v[164:167], v[64:67]
    v_mul_f32 v4, s59, v4
    v_mul_f32 v5, s59, v5
    v_mfma_f32_16x16x32_bf16 v[92:95], v[180:183], v[168:171], v[92:95]
    v_mul_f32 v6, s59, v6
    v_mul_f32 v7, s59, v7
    v_mfma_f32_16x16x32_bf16 v[12:15], v[184:187], v[156:159], v[12:15]
    v_cvt_pk_bf16_f32 v112, v0, v1
    v_cvt_pk_bf16_f32 v113, v2, v3
    v_mfma_f32_16x16x32_bf16 v[40:43], v[184:187], v[160:163], v[40:43]
    v_cvt_pk_bf16_f32 v114, v4, v5
    v_cvt_pk_bf16_f32 v115, v6, v7
    buffer_store_dwordx4 v[112:115], v208, s[8:11], s60 offen offset:0
    v_mfma_f32_16x16x32_bf16 v[68:71], v[184:187], v[164:167], v[68:71]
    v_mul_f32 v28, s59, v28
    v_mul_f32 v29, s59, v29
    v_mfma_f32_16x16x32_bf16 v[96:99], v[184:187], v[168:171], v[96:99]
    v_mul_f32 v30, s59, v30
    v_mul_f32 v31, s59, v31
    v_mul_f32 v32, s59, v32
    v_mul_f32 v33, s59, v33
    v_mul_f32 v34, s59, v34
    v_mul_f32 v35, s59, v35
    v_cvt_pk_bf16_f32 v116, v28, v29
    v_cvt_pk_bf16_f32 v117, v30, v31
    v_cvt_pk_bf16_f32 v118, v32, v33
    v_cvt_pk_bf16_f32 v119, v34, v35
    buffer_store_dwordx4 v[116:119], v208, s[8:11], s60 offen offset:256
    v_mul_f32 v56, s59, v56
    v_mul_f32 v57, s59, v57
    v_mul_f32 v58, s59, v58
    v_mul_f32 v59, s59, v59
    v_mul_f32 v60, s59, v60
    v_mul_f32 v61, s59, v61
    v_mul_f32 v62, s59, v62
    v_mul_f32 v63, s59, v63
    v_cvt_pk_bf16_f32 v120, v56, v57
    v_cvt_pk_bf16_f32 v121, v58, v59
    v_cvt_pk_bf16_f32 v122, v60, v61
    v_cvt_pk_bf16_f32 v123, v62, v63
    buffer_store_dwordx4 v[120:123], v208, s[8:11], s60 offen offset:1024
    v_mul_f32 v84, s59, v84
    v_mul_f32 v85, s59, v85
    v_mul_f32 v86, s59, v86
    v_mul_f32 v87, s59, v87
    v_mul_f32 v88, s59, v88
    v_mul_f32 v89, s59, v89
    v_mul_f32 v90, s59, v90
    v_mul_f32 v91, s59, v91
    v_cvt_pk_bf16_f32 v124, v84, v85
    v_cvt_pk_bf16_f32 v125, v86, v87
    v_cvt_pk_bf16_f32 v126, v88, v89
    v_cvt_pk_bf16_f32 v127, v90, v91
    buffer_store_dwordx4 v[124:127], v208, s[8:11], s60 offen offset:1280
    s_branch .Lqkv_ep_n0
.Lqkv_ep_k0:
    v_mfma_f32_16x16x32_bf16 v[8:11], v[180:183], v[156:159], v[8:11]
    v_cvt_pk_bf16_f32 v112, v0, v1
    v_cvt_pk_bf16_f32 v113, v2, v3
    v_mfma_f32_16x16x32_bf16 v[36:39], v[180:183], v[160:163], v[36:39]
    v_cvt_pk_bf16_f32 v114, v4, v5
    v_cvt_pk_bf16_f32 v115, v6, v7
    buffer_store_dwordx4 v[112:115], v208, s[8:11], s60 offen offset:0
    v_mfma_f32_16x16x32_bf16 v[64:67], v[180:183], v[164:167], v[64:67]
    v_cvt_pk_bf16_f32 v116, v28, v29
    v_cvt_pk_bf16_f32 v117, v30, v31
    v_mfma_f32_16x16x32_bf16 v[92:95], v[180:183], v[168:171], v[92:95]
    v_cvt_pk_bf16_f32 v118, v32, v33
    v_cvt_pk_bf16_f32 v119, v34, v35
    buffer_store_dwordx4 v[116:119], v208, s[8:11], s60 offen offset:256
    v_mfma_f32_16x16x32_bf16 v[12:15], v[184:187], v[156:159], v[12:15]
    v_cvt_pk_bf16_f32 v120, v56, v57
    v_cvt_pk_bf16_f32 v121, v58, v59
    v_mfma_f32_16x16x32_bf16 v[40:43], v[184:187], v[160:163], v[40:43]
    v_cvt_pk_bf16_f32 v122, v60, v61
    v_cvt_pk_bf16_f32 v123, v62, v63
    buffer_store_dwordx4 v[120:123], v208, s[8:11], s60 offen offset:1024
    v_mfma_f32_16x16x32_bf16 v[68:71], v[184:187], v[164:167], v[68:71]
    v_cvt_pk_bf16_f32 v124, v84, v85
    v_cvt_pk_bf16_f32 v125, v86, v87
    v_mfma_f32_16x16x32_bf16 v[96:99], v[184:187], v[168:171], v[96:99]
    v_cvt_pk_bf16_f32 v126, v88, v89
    v_cvt_pk_bf16_f32 v127, v90, v91
    buffer_store_dwordx4 v[124:127], v208, s[8:11], s60 offen offset:1280
    s_branch .Lqkv_ep_n0
.Lqkv_ep_v0:
    s_add_u32 s60, s60, 2816
    v_mfma_f32_16x16x32_bf16 v[8:11], v[180:183], v[156:159], v[8:11]
    v_cvt_pk_bf16_f32 v112, v0, v1
    v_cvt_pk_bf16_f32 v113, v2, v3
    v_mfma_f32_16x16x32_bf16 v[36:39], v[180:183], v[160:163], v[36:39]
    v_cvt_pk_bf16_f32 v114, v4, v5
    v_cvt_pk_bf16_f32 v115, v6, v7
    buffer_store_dwordx4 v[112:115], v209, s[8:11], s60 offen offset:0
    v_mfma_f32_16x16x32_bf16 v[64:67], v[180:183], v[164:167], v[64:67]
    v_cvt_pk_bf16_f32 v116, v28, v29
    v_cvt_pk_bf16_f32 v117, v30, v31
    v_mfma_f32_16x16x32_bf16 v[92:95], v[180:183], v[168:171], v[92:95]
    v_cvt_pk_bf16_f32 v118, v32, v33
    v_cvt_pk_bf16_f32 v119, v34, v35
    buffer_store_dwordx4 v[116:119], v209, s[8:11], s60 offen offset:512
    v_mfma_f32_16x16x32_bf16 v[12:15], v[184:187], v[156:159], v[12:15]
    v_cvt_pk_bf16_f32 v120, v56, v57
    v_cvt_pk_bf16_f32 v121, v58, v59
    v_mfma_f32_16x16x32_bf16 v[40:43], v[184:187], v[160:163], v[40:43]
    v_cvt_pk_bf16_f32 v122, v60, v61
    v_cvt_pk_bf16_f32 v123, v62, v63
    buffer_store_dwordx4 v[120:123], v209, s[8:11], s60 offen offset:1024
    v_mfma_f32_16x16x32_bf16 v[68:71], v[184:187], v[164:167], v[68:71]
    v_cvt_pk_bf16_f32 v124, v84, v85
    v_cvt_pk_bf16_f32 v125, v86, v87
    v_mfma_f32_16x16x32_bf16 v[96:99], v[184:187], v[168:171], v[96:99]
    v_cvt_pk_bf16_f32 v126, v88, v89
    v_cvt_pk_bf16_f32 v127, v90, v91
    buffer_store_dwordx4 v[124:127], v209, s[8:11], s60 offen offset:1536
.Lqkv_ep_n0:
    s_add_u32 s52, s54, 2
    s_lshr_b32 s53, s52, 3
    s_and_b32 s52, s52, 7
    s_add_u32 s52, s52, s56
    s_mul_i32 s52, s52, 229376
    s_cmp_eq_u32 s53, 0
    s_cselect_b32 s59, s57, s58
    s_add_u32 s60, s52, s59
    s_cmp_eq_u32 s53, 2
    s_cbranch_scc1 .Lqkv_ep_v1
    s_cmp_eq_u32 s53, 0
    s_cbranch_scc0 .Lqkv_ep_k1
    s_mov_b32 s59, 0x3eae1a93
    v_mfma_f32_16x16x32_bf16 v[16:19], v[188:191], v[156:159], v[16:19]
    v_mul_f32 v8, s59, v8
    v_mul_f32 v9, s59, v9
    v_mfma_f32_16x16x32_bf16 v[44:47], v[188:191], v[160:163], v[44:47]
    v_mul_f32 v10, s59, v10
    v_mul_f32 v11, s59, v11
    v_mfma_f32_16x16x32_bf16 v[72:75], v[188:191], v[164:167], v[72:75]
    v_mul_f32 v12, s59, v12
    v_mul_f32 v13, s59, v13
    v_mfma_f32_16x16x32_bf16 v[100:103], v[188:191], v[168:171], v[100:103]
    v_mul_f32 v14, s59, v14
    v_mul_f32 v15, s59, v15
    v_mfma_f32_16x16x32_bf16 v[20:23], v[192:195], v[156:159], v[20:23]
    v_cvt_pk_bf16_f32 v128, v8, v9
    v_cvt_pk_bf16_f32 v129, v10, v11
    v_mfma_f32_16x16x32_bf16 v[48:51], v[192:195], v[160:163], v[48:51]
    v_cvt_pk_bf16_f32 v130, v12, v13
    v_cvt_pk_bf16_f32 v131, v14, v15
    buffer_store_dwordx4 v[128:131], v208, s[8:11], s60 offen offset:0
    v_mfma_f32_16x16x32_bf16 v[76:79], v[192:195], v[164:167], v[76:79]
    v_mul_f32 v36, s59, v36
    v_mul_f32 v37, s59, v37
    v_mfma_f32_16x16x32_bf16 v[104:107], v[192:195], v[168:171], v[104:107]
    v_mul_f32 v38, s59, v38
    v_mul_f32 v39, s59, v39
    v_mul_f32 v40, s59, v40
    v_mul_f32 v41, s59, v41
    v_mul_f32 v42, s59, v42
    v_mul_f32 v43, s59, v43
    v_cvt_pk_bf16_f32 v132, v36, v37
    v_cvt_pk_bf16_f32 v133, v38, v39
    v_cvt_pk_bf16_f32 v134, v40, v41
    v_cvt_pk_bf16_f32 v135, v42, v43
    buffer_store_dwordx4 v[132:135], v208, s[8:11], s60 offen offset:256
    v_mul_f32 v64, s59, v64
    v_mul_f32 v65, s59, v65
    v_mul_f32 v66, s59, v66
    v_mul_f32 v67, s59, v67
    v_mul_f32 v68, s59, v68
    v_mul_f32 v69, s59, v69
    v_mul_f32 v70, s59, v70
    v_mul_f32 v71, s59, v71
    v_cvt_pk_bf16_f32 v136, v64, v65
    v_cvt_pk_bf16_f32 v137, v66, v67
    v_cvt_pk_bf16_f32 v138, v68, v69
    v_cvt_pk_bf16_f32 v139, v70, v71
    buffer_store_dwordx4 v[136:139], v208, s[8:11], s60 offen offset:1024
    v_mul_f32 v92, s59, v92
    v_mul_f32 v93, s59, v93
    v_mul_f32 v94, s59, v94
    v_mul_f32 v95, s59, v95
    v_mul_f32 v96, s59, v96
    v_mul_f32 v97, s59, v97
    v_mul_f32 v98, s59, v98
    v_mul_f32 v99, s59, v99
    v_cvt_pk_bf16_f32 v140, v92, v93
    v_cvt_pk_bf16_f32 v141, v94, v95
    v_cvt_pk_bf16_f32 v142, v96, v97
    v_cvt_pk_bf16_f32 v143, v98, v99
    buffer_store_dwordx4 v[140:143], v208, s[8:11], s60 offen offset:1280
    s_branch .Lqkv_ep_n1
.Lqkv_ep_k1:
    v_mfma_f32_16x16x32_bf16 v[16:19], v[188:191], v[156:159], v[16:19]
    v_cvt_pk_bf16_f32 v128, v8, v9
    v_cvt_pk_bf16_f32 v129, v10, v11
    v_mfma_f32_16x16x32_bf16 v[44:47], v[188:191], v[160:163], v[44:47]
    v_cvt_pk_bf16_f32 v130, v12, v13
    v_cvt_pk_bf16_f32 v131, v14, v15
    buffer_store_dwordx4 v[128:131], v208, s[8:11], s60 offen offset:0
    v_mfma_f32_16x16x32_bf16 v[72:75], v[188:191], v[164:167], v[72:75]
    v_cvt_pk_bf16_f32 v132, v36, v37
    v_cvt_pk_bf16_f32 v133, v38, v39
    v_mfma_f32_16x16x32_bf16 v[100:103], v[188:191], v[168:171], v[100:103]
    v_cvt_pk_bf16_f32 v134, v40, v41
    v_cvt_pk_bf16_f32 v135, v42, v43
    buffer_store_dwordx4 v[132:135], v208, s[8:11], s60 offen offset:256
    v_mfma_f32_16x16x32_bf16 v[20:23], v[192:195], v[156:159], v[20:23]
    v_cvt_pk_bf16_f32 v136, v64, v65
    v_cvt_pk_bf16_f32 v137, v66, v67
    v_mfma_f32_16x16x32_bf16 v[48:51], v[192:195], v[160:163], v[48:51]
    v_cvt_pk_bf16_f32 v138, v68, v69
    v_cvt_pk_bf16_f32 v139, v70, v71
    buffer_store_dwordx4 v[136:139], v208, s[8:11], s60 offen offset:1024
    v_mfma_f32_16x16x32_bf16 v[76:79], v[192:195], v[164:167], v[76:79]
    v_cvt_pk_bf16_f32 v140, v92, v93
    v_cvt_pk_bf16_f32 v141, v94, v95
    v_mfma_f32_16x16x32_bf16 v[104:107], v[192:195], v[168:171], v[104:107]
    v_cvt_pk_bf16_f32 v142, v96, v97
    v_cvt_pk_bf16_f32 v143, v98, v99
    buffer_store_dwordx4 v[140:143], v208, s[8:11], s60 offen offset:1280
    s_branch .Lqkv_ep_n1
.Lqkv_ep_v1:
    s_add_u32 s60, s60, 2816
    v_mfma_f32_16x16x32_bf16 v[16:19], v[188:191], v[156:159], v[16:19]
    v_cvt_pk_bf16_f32 v128, v8, v9
    v_cvt_pk_bf16_f32 v129, v10, v11
    v_mfma_f32_16x16x32_bf16 v[44:47], v[188:191], v[160:163], v[44:47]
    v_cvt_pk_bf16_f32 v130, v12, v13
    v_cvt_pk_bf16_f32 v131, v14, v15
    buffer_store_dwordx4 v[128:131], v209, s[8:11], s60 offen offset:0
    v_mfma_f32_16x16x32_bf16 v[72:75], v[188:191], v[164:167], v[72:75]
    v_cvt_pk_bf16_f32 v132, v36, v37
    v_cvt_pk_bf16_f32 v133, v38, v39
    v_mfma_f32_16x16x32_bf16 v[100:103], v[188:191], v[168:171], v[100:103]
    v_cvt_pk_bf16_f32 v134, v40, v41
    v_cvt_pk_bf16_f32 v135, v42, v43
    buffer_store_dwordx4 v[132:135], v209, s[8:11], s60 offen offset:512
    v_mfma_f32_16x16x32_bf16 v[20:23], v[192:195], v[156:159], v[20:23]
    v_cvt_pk_bf16_f32 v136, v64, v65
    v_cvt_pk_bf16_f32 v137, v66, v67
    v_mfma_f32_16x16x32_bf16 v[48:51], v[192:195], v[160:163], v[48:51]
    v_cvt_pk_bf16_f32 v138, v68, v69
    v_cvt_pk_bf16_f32 v139, v70, v71
    buffer_store_dwordx4 v[136:139], v209, s[8:11], s60 offen offset:1024
    v_mfma_f32_16x16x32_bf16 v[76:79], v[192:195], v[164:167], v[76:79]
    v_cvt_pk_bf16_f32 v140, v92, v93
    v_cvt_pk_bf16_f32 v141, v94, v95
    v_mfma_f32_16x16x32_bf16 v[104:107], v[192:195], v[168:171], v[104:107]
    v_cvt_pk_bf16_f32 v142, v96, v97
    v_cvt_pk_bf16_f32 v143, v98, v99
    buffer_store_dwordx4 v[140:143], v209, s[8:11], s60 offen offset:1536
.Lqkv_ep_n1:
    s_add_u32 s52, s54, 4
    s_lshr_b32 s53, s52, 3
    s_and_b32 s52, s52, 7
    s_add_u32 s52, s52, s56
    s_mul_i32 s52, s52, 229376
    s_cmp_eq_u32 s53, 0
    s_cselect_b32 s59, s57, s58
    s_add_u32 s60, s52, s59
    s_cmp_eq_u32 s53, 2
    s_cbranch_scc1 .Lqkv_ep_v2
    s_cmp_eq_u32 s53, 0
    s_cbranch_scc0 .Lqkv_ep_k2
    s_mov_b32 s59, 0x3eae1a93
    v_mfma_f32_16x16x32_bf16 v[24:27], v[196:199], v[156:159], v[24:27]
    v_mul_f32 v16, s59, v16
    v_mul_f32 v17, s59, v17
    v_mfma_f32_16x16x32_bf16 v[52:55], v[196:199], v[160:163], v[52:55]
    v_mul_f32 v18, s59, v18
    v_mul_f32 v19, s59, v19
    v_mfma_f32_16x16x32_bf16 v[80:83], v[196:199], v[164:167], v[80:83]
    v_mul_f32 v20, s59, v20
    v_mul_f32 v21, s59, v21
    v_mfma_f32_16x16x32_bf16 v[108:111], v[196:199], v[168:171], v[108:111]
    v_mul_f32 v22, s59, v22
    v_mul_f32 v23, s59, v23
    v_cvt_pk_bf16_f32 v144, v16, v17
    v_cvt_pk_bf16_f32 v145, v18, v19
    v_cvt_pk_bf16_f32 v146, v20, v21
    v_cvt_pk_bf16_f32 v147, v22, v23
    buffer_store_dwordx4 v[144:147], v208, s[8:11], s60 offen offset:0
    v_mul_f32 v44, s59, v44
    v_mul_f32 v45, s59, v45
    v_mul_f32 v46, s59, v46
    v_mul_f32 v47, s59, v47
    v_mul_f32 v48, s59, v48
    v_mul_f32 v49, s59, v49
    v_mul_f32 v50, s59, v50
    v_mul_f32 v51, s59, v51
    v_cvt_pk_bf16_f32 v148, v44, v45
    v_cvt_pk_bf16_f32 v149, v46, v47
    v_cvt_pk_bf16_f32 v150, v48, v49
    v_cvt_pk_bf16_f32 v151, v50, v51
    buffer_store_dwordx4 v[148:151], v208, s[8:11], s60 offen offset:256
    v_mul_f32 v72, s59, v72
    v_mul_f32 v73, s59, v73
    v_mul_f32 v74, s59, v74
    v_mul_f32 v75, s59, v75
    v_mul_f32 v76, s59, v76
    v_mul_f32 v77, s59, v77
    v_mul_f32 v78, s59, v78
    v_mul_f32 v79, s59, v79
    v_cvt_pk_bf16_f32 v224, v72, v73
    v_cvt_pk_bf16_f32 v225, v74, v75
    v_cvt_pk_bf16_f32 v226, v76, v77
    v_cvt_pk_bf16_f32 v227, v78, v79
    buffer_store_dwordx4 v[224:227], v208, s[8:11], s60 offen offset:1024
    v_mul_f32 v100, s59, v100
    v_mul_f32 v101, s59, v101
    v_mul_f32 v102, s59, v102
    v_mul_f32 v103, s59, v103
    v_mul_f32 v104, s59, v104
    v_mul_f32 v105, s59, v105
    v_mul_f32 v106, s59, v106
    v_mul_f32 v107, s59, v107
    v_cvt_pk_bf16_f32 v228, v100, v101
    v_cvt_pk_bf16_f32 v229, v102, v103
    v_cvt_pk_bf16_f32 v230, v104, v105
    v_cvt_pk_bf16_f32 v231, v106, v107
    buffer_store_dwordx4 v[228:231], v208, s[8:11], s60 offen offset:1280
    s_branch .Lqkv_ep_n2
.Lqkv_ep_k2:
    v_mfma_f32_16x16x32_bf16 v[24:27], v[196:199], v[156:159], v[24:27]
    v_cvt_pk_bf16_f32 v144, v16, v17
    v_cvt_pk_bf16_f32 v145, v18, v19
    v_mfma_f32_16x16x32_bf16 v[52:55], v[196:199], v[160:163], v[52:55]
    v_cvt_pk_bf16_f32 v146, v20, v21
    v_cvt_pk_bf16_f32 v147, v22, v23
    buffer_store_dwordx4 v[144:147], v208, s[8:11], s60 offen offset:0
    v_mfma_f32_16x16x32_bf16 v[80:83], v[196:199], v[164:167], v[80:83]
    v_cvt_pk_bf16_f32 v148, v44, v45
    v_cvt_pk_bf16_f32 v149, v46, v47
    v_mfma_f32_16x16x32_bf16 v[108:111], v[196:199], v[168:171], v[108:111]
    v_cvt_pk_bf16_f32 v150, v48, v49
    v_cvt_pk_bf16_f32 v151, v50, v51
    buffer_store_dwordx4 v[148:151], v208, s[8:11], s60 offen offset:256
    v_cvt_pk_bf16_f32 v224, v72, v73
    v_cvt_pk_bf16_f32 v225, v74, v75
    v_cvt_pk_bf16_f32 v226, v76, v77
    v_cvt_pk_bf16_f32 v227, v78, v79
    buffer_store_dwordx4 v[224:227], v208, s[8:11], s60 offen offset:1024
    v_cvt_pk_bf16_f32 v228, v100, v101
    v_cvt_pk_bf16_f32 v229, v102, v103
    v_cvt_pk_bf16_f32 v230, v104, v105
    v_cvt_pk_bf16_f32 v231, v106, v107
    buffer_store_dwordx4 v[228:231], v208, s[8:11], s60 offen offset:1280
    s_branch .Lqkv_ep_n2
.Lqkv_ep_v2:
    s_add_u32 s60, s60, 2816
    v_mfma_f32_16x16x32_bf16 v[24:27], v[196:199], v[156:159], v[24:27]
    v_cvt_pk_bf16_f32 v144, v16, v17
    v_cvt_pk_bf16_f32 v145, v18, v19
    v_mfma_f32_16x16x32_bf16 v[52:55], v[196:199], v[160:163], v[52:55]
    v_cvt_pk_bf16_f32 v146, v20, v21
    v_cvt_pk_bf16_f32 v147, v22, v23
    buffer_store_dwordx4 v[144:147], v209, s[8:11], s60 offen offset:0
    v_mfma_f32_16x16x32_bf16 v[80:83], v[196:199], v[164:167], v[80:83]
    v_cvt_pk_bf16_f32 v148, v44, v45
    v_cvt_pk_bf16_f32 v149, v46, v47
    v_mfma_f32_16x16x32_bf16 v[108:111], v[196:199], v[168:171], v[108:111]
    v_cvt_pk_bf16_f32 v150, v48, v49
    v_cvt_pk_bf16_f32 v151, v50, v51
    buffer_store_dwordx4 v[148:151], v209, s[8:11], s60 offen offset:512
    v_cvt_pk_bf16_f32 v224, v72, v73
    v_cvt_pk_bf16_f32 v225, v74, v75
    v_cvt_pk_bf16_f32 v226, v76, v77
    v_cvt_pk_bf16_f32 v227, v78, v79
    buffer_store_dwordx4 v[224:227], v209, s[8:11], s60 offen offset:1024
    v_cvt_pk_bf16_f32 v228, v100, v101
    v_cvt_pk_bf16_f32 v229, v102, v103
    v_cvt_pk_bf16_f32 v230, v104, v105
    v_cvt_pk_bf16_f32 v231, v106, v107
    buffer_store_dwordx4 v[228:231], v209, s[8:11], s60 offen offset:1536
.Lqkv_ep_n2:
    v_mul_f32 v24, v212, v24
    v_mul_f32 v25, v212, v25
    v_mul_f32 v26, v212, v26
    v_mul_f32 v27, v212, v27
    v_cvt_pk_bf16_f32 v160, v24, v25
    v_cvt_pk_bf16_f32 v164, v26, v27
    v_mul_f32 v52, v212, v52
    v_mul_f32 v53, v212, v53
    v_mul_f32 v54, v212, v54
    v_mul_f32 v55, v212, v55
    v_cvt_pk_bf16_f32 v161, v52, v53
    v_cvt_pk_bf16_f32 v165, v54, v55
    v_mul_f32 v80, v212, v80
    v_mul_f32 v81, v212, v81
    v_mul_f32 v82, v212, v82
    v_mul_f32 v83, v212, v83
    v_cvt_pk_bf16_f32 v162, v80, v81
    v_cvt_pk_bf16_f32 v166, v82, v83
    v_mul_f32 v108, v212, v108
    v_mul_f32 v109, v212, v109
    v_mul_f32 v110, v212, v110
    v_mul_f32 v111, v212, v111
    v_cvt_pk_bf16_f32 v163, v108, v109
    v_cvt_pk_bf16_f32 v167, v110, v111
    s_mov_b32 s59, 229376
    s_cmp_ge_u32 s54, 16
    s_cbranch_scc1 .Lqkv_ex_v
    buffer_store_dwordx4 v[160:163], v210, s[8:11], 0 offen
    buffer_store_dwordx4 v[164:167], v210, s[8:11], s59 offen
    s_cmp_ge_u32 s54, 12
    s_cbranch_scc0 .Lp1_join
.Lqkv_ex_v:
    v_mov_b32 v168, v160
    v_mov_b32 v169, 0x3f80
    v_mov_b32 v170, v161
    v_mov_b32 v171, 0x3f80
    v_mov_b32 v172, v162
    v_mov_b32 v173, 0x3f80
    v_mov_b32 v174, v163
    v_mov_b32 v175, 0x3f80
    v_mov_b32 v176, v164
    v_mov_b32 v177, 0x3f80
    v_mov_b32 v178, v165
    v_mov_b32 v179, 0x3f80
    v_mov_b32 v180, v166
    v_mov_b32 v181, 0x3f80
    v_mov_b32 v182, v167
    v_mov_b32 v183, 0x3f80
    buffer_store_dwordx4 v[168:171], v211, s[8:11], 0 offen offset:0
    buffer_store_dwordx4 v[172:175], v211, s[8:11], 0 offen offset:16
    buffer_store_dwordx4 v[176:179], v211, s[8:11], s59 offen offset:0
    buffer_store_dwordx4 v[180:183], v211, s[8:11], s59 offen offset:16
.Lp1_join:
    s_waitcnt vmcnt(0)
    s_barrier
.Lp1_done:
    s_lshl_b32 s48, s4, 3
    s_lshr_b32 s49, s5, 2
    s_add_u32 s48, s48, s49
    s_and_b32 s49, s5, 3
    s_lshl_b32 s49, s49, 3
    s_add_u32 s49, s49, s3
    s_mul_i32 s50, s48, 229376
    s_mul_i32 s51, s49, 2304
    s_add_u32 s51, s51, s50
    s_add_u32 s51, s51, 155648
    s_lshl_b32 s52, s3, 10
    s_add_u32 s53, s50, s52
    s_mov_b32 m0, s52
    v_and_b32 v2, 15, v252
    v_lshrrev_b32 v3, 4, v252
    v_lshrrev_b32 v4, 1, v3
    v_lshlrev_b32 v4, 8, v4
    v_lshrrev_b32 v5, 2, v2
    v_lshl_add_u32 v4, v5, 5, v4
    v_and_b32 v6, 1, v2
    v_bfe_u32 v7, v2, 1, 1
    v_lshl_add_u32 v6, v6, 1, v7
    v_lshlrev_b32 v6, 3, v6
    v_add_u32 v6, 2816, v6
    v_and_b32 v9, 3, v2
    v_cmp_eq_u32 vcc, 0, v9
    v_mov_b32 v9, 0x40000
    v_mov_b32 v7, 2176
    v_and_b32 v8, 1, v3
    v_cndmask_b32 v7, v9, v7, vcc
    v_cmp_eq_u32 vcc, 0, v8
    v_mov_b32 v9, 512
    v_and_b32 v1, 7, v2
    v_cndmask_b32 v6, v7, v6, vcc
    v_cndmask_b32 v9, 8, v9, vcc
    v_add_u32 v144, v4, v6
    v_add_u32 v145, v144, v9
    v_add_u32 v146, v145, v9
    v_add_u32 v147, v146, v9
    v_lshlrev_b32 v1, 4, v1
    v_lshl_add_u32 v1, v3, 2, v1
    v_lshrrev_b32 v5, 3, v2
    v_mul_u32_u24 v5, 640, v5
    v_add_u32 v1, 2048, v1
    v_add_u32 v121, v1, v5
    v_lshlrev_b32 v1, 2, v8
    v_lshl_add_u32 v254, v2, 4, v1
    v_lshlrev_b32 v119, 4, v252
    v_mov_b32 v120, v121
    v_mov_b32 v140, v144
    v_mov_b32 v141, v145
    v_mov_b32 v142, v146
    v_mov_b32 v143, v147
    v_mov_b32 v118, 0xdddddddd
    v_mov_b32 v117, 0x3f803f80
    v_mov_b32 v64, 0
    v_mov_b32 v65, 0
    v_mov_b32 v66, 0
    v_mov_b32 v67, 0
    v_mov_b32 v68, 0
    v_mov_b32 v69, 0
    v_mov_b32 v70, 0
    v_mov_b32 v71, 0
    v_mov_b32 v72, 0
    v_mov_b32 v73, 0
    v_mov_b32 v74, 0
    v_mov_b32 v75, 0
    v_mov_b32 v76, 0
    v_mov_b32 v77, 0
    v_mov_b32 v78, 0
    v_mov_b32 v79, 0
    v_mov_b32 v80, 0
    v_mov_b32 v81, 0
    v_mov_b32 v82, 0
    v_mov_b32 v83, 0
    v_mov_b32 v84, 0
    v_mov_b32 v85, 0
    v_mov_b32 v86, 0
    v_mov_b32 v87, 0
    v_mov_b32 v88, 0
    v_mov_b32 v89, 0
    v_mov_b32 v90, 0
    v_mov_b32 v91, 0
    v_mov_b32 v92, 0
    v_mov_b32 v93, 0
    v_mov_b32 v94, 0
    v_mov_b32 v95, 0
    s_mov_b32 s55, 0
    s_setprio 1
.Lp2_join:
    s_barrier
    buffer_load_dwordx4 v[96:99], v119, s[8:11], s51 offen sc1
    buffer_load_dwordx4 v119, s[8:11], s53 offen sc1 lds
    buffer_load_dwordx4 v[100:103], v119, s[8:11], s51 offen offset:1024 sc1
    s_add_u32 m0, m0, 8192
    s_add_u32 s53, s53, 8192
    buffer_load_dwordx4 v119, s[8:11], s53 offen offset:0 sc1 lds
    buffer_load_dword v104, v254, s[8:11], s51 offen offset:2048 sc1
    buffer_load_dword v106, v254, s[8:11], s51 offen offset:2056 sc1
    s_waitcnt vmcnt(0)
    s_barrier
    ds_read_b128 v[108:111], v119
    ds_read_b128 v[112:115], v119 offset:1024
    ds_read_b32 v116, v120
    ds_read_b64_tr_b16 v[124:125], v140 offset:0
    ds_read_b64_tr_b16 v[126:127], v140 offset:128
    ds_read_b64_tr_b16 v[128:129], v141 offset:0
    ds_read_b64_tr_b16 v[130:131], v141 offset:128
    ds_read_b64_tr_b16 v[132:133], v142 offset:0
    ds_read_b64_tr_b16 v[134:135], v142 offset:128
    s_waitcnt lgkmcnt(8)
    v_mfma_f32_32x32x16_bf16 v[0:15], v[108:111], v[96:99], 0
    v_mfma_f32_32x32x16_bf16 v[32:47], v[108:111], v[100:103], 0
    s_waitcnt lgkmcnt(7)
    v_mfma_f32_32x32x16_bf16 v[16:31], v[112:115], v[96:99], 0
    s_add_u32 m0, m0, 8192
    s_add_u32 s53, s53, 8192
    buffer_load_dwordx4 v119, s[8:11], s53 offen offset:0 sc1 lds
    s_mul_i32 s59, s3, 3072
    s_add_u32 s59, s59, 8192
    s_add_u32 m0, m0, s59
    s_add_u32 s53, s53, s59
    buffer_load_dwordx4 v119, s[8:11], s53 offen offset:0 sc1 lds
    buffer_load_dwordx4 v119, s[8:11], s53 offen offset:1024 sc1 lds
    s_nop 0
    v_max3_f32 v48, v0, v1, v2
    v_max3_f32 v48, v3, v4, v48
    v_max3_f32 v48, v5, v6, v48
    v_max3_f32 v48, v7, v8, v48
    v_max3_f32 v48, v9, v10, v48
    v_max3_f32 v48, v11, v12, v48
    v_max3_f32 v48, v13, v14, v48
    v_max_f32 v48, v15, v48
    v_max3_f32 v49, v32, v33, v34
    v_max3_f32 v49, v35, v36, v49
    v_max3_f32 v49, v37, v38, v49
    v_max3_f32 v49, v39, v40, v49
    v_max3_f32 v49, v41, v42, v49
    v_max3_f32 v49, v43, v44, v49
    v_max3_f32 v49, v45, v46, v49
    v_max_f32 v49, v47, v49
    v_mov_b32 v50, v48
    v_mov_b32 v51, v49
    s_nop 1
    v_permlane32_swap_b32 v48, v50
    v_permlane32_swap_b32 v49, v51
    s_nop 1
    v_max_f32 v48, v48, v50
    v_max_f32 v49, v49, v51
    v_cvt_pk_bf16_f32 v105, -v48, 0
    v_cvt_pk_bf16_f32 v107, -v49, 0
    s_waitcnt lgkmcnt(0)
    s_nop 0
    v_mfma_f32_32x32x4_2b_bf16 v[0:31], v[116:117], v[104:105], v[0:31]
    s_lshr_b32 s56, s5, 2
    s_lshl_b32 s56, s56, 3
    s_add_u32 s56, s56, s3
    s_lshl_b32 s57, s56, 4
    s_and_b32 s59, s5, 3
    s_lshl_b32 s59, s59, 8
    s_lshl_b32 s60, s4, 2
    s_add_u32 s59, s59, s60
    s_sub_u32 s59, s59, 128
    v_lshl_add_u32 v246, v252, 2, s57
    v_lshl_add_u32 v247, v252, 5, s59
    v_cmp_gt_u32 vcc, 4, v252
    s_mov_b32 s57, 14699520
    v_and_b32 v247, 0x3ff, v247
    v_cndmask_b32 v246, v247, v246, vcc
    s_mul_i32 s56, s56, 23040
    s_add_u32 s24, s56, 20447232
    s_and_b32 s58, s3, 3
    s_lshl_b32 s58, s58, 6
    s_lshl_b32 s59, s4, 10
    s_add_u32 s58, s58, s59
    s_and_b32 s59, s5, 3
    s_lshl_b32 s59, s59, 8
    s_add_u32 s58, s58, s59
    s_add_u32 s25, s58, 14680064
    v_lshlrev_b32 v254, 2, v252
    v_lshlrev_b32 v148, 4, v252
    v_lshlrev_b32 v149, 3, v252
    v_and_b32 v150, 60, v254
    v_add_u32 v151, 4096, v148
    v_and_b32 v255, 8, v252
    v_lshlrev_b32 v255, 28, v255
    v_or_b32 v151, v151, v255
    s_cmp_ge_u32 s3, 4
    s_cbranch_scc0 .Lwo_done
    s_cmp_eq_u32 s3, 4
    s_cbranch_scc0 .Lside_ready
    v_dot2c_f32_bf16 v161, v152, v164
    v_dot2c_f32_bf16 v161, v153, v165
    v_dot2c_f32_bf16 v161, v154, v166
    v_dot2c_f32_bf16 v161, v155, v167
    v_dot2c_f32_bf16 v161, v156, v168
    v_dot2c_f32_bf16 v161, v157, v169
    v_dot2c_f32_bf16 v161, v158, v170
    v_dot2c_f32_bf16 v161, v159, v171
    v_dot2c_f32_bf16 v161, v160, v172
    s_nop 2
    v_add_f32_dpp v161, v161, v161 quad_perm:[1,0,3,2] row_mask:0xf bank_mask:0xf
    s_nop 1
    v_add_f32_dpp v161, v161, v161 quad_perm:[2,3,0,1] row_mask:0xf bank_mask:0xf
    s_nop 1
    v_add_f32_dpp v161, v161, v161 row_half_mirror row_mask:0xf bank_mask:0xf
    s_nop 1
    v_add_f32_dpp v161, v161, v161 row_mirror row_mask:0xf bank_mask:0xf
    s_nop 1
    v_mov_b32 v162, v161
    s_nop 1
    v_permlane16_swap_b32 v161, v162
    s_nop 1
    v_add_f32 v161, v161, v162
    v_mul_f32 v161, 0xbfb8aa3b, v161
    v_exp_f32 v161, v161
    s_nop 0
    v_add_f32 v161, 1.0, v161
    v_rcp_f32 v161, v161
    s_nop 0
    v_sub_f32 v162, 1.0, v161
    v_lshl_or_b32 v220, v221, 16, v220
    v_lshl_or_b32 v221, v223, 16, v222
    v_lshl_or_b32 v222, v225, 16, v224
    v_lshl_or_b32 v223, v227, 16, v226
    v_lshl_or_b32 v228, v229, 16, v228
    v_lshl_or_b32 v229, v231, 16, v230
    v_lshl_or_b32 v230, v233, 16, v232
    v_lshl_or_b32 v231, v235, 16, v234
.Lside_ready:
    s_mov_b32 s60, 14680064
    s_mov_b32 s61, 14688256
    buffer_store_dword v161, v174, s[8:11], s60 offen sc1
    buffer_store_dword v162, v174, s[8:11], s61 offen sc1
    s_lshr_b32 s60, s2, 2
    s_mul_i32 s60, s60, 23040
    s_add_u32 s60, s60, 20447232
    s_mul_i32 s61, s62, 5120
    s_add_u32 s61, s61, s60
    s_sub_u32 s63, s3, 4
    s_lshl_b32 s63, s63, 10
    s_add_u32 s63, s63, s61
    buffer_store_dwordx4 v[220:223], v119, s[8:11], s63 offen sc1
    s_cmp_eq_u32 s66, 0
    s_cbranch_scc1 .Lwo_done
    s_cmp_eq_u32 s3, 4
    s_cbranch_scc0 .Lwo_extra
    s_add_u32 s61, s61, 4096
    buffer_store_dwordx4 v[228:231], v119, s[8:11], s61 offen sc1
    s_branch .Lwo_done
.Lwo_extra:
    s_lshl_b32 s61, s67, 9
    s_add_u32 s61, s61, s60
    s_add_u32 s61, s61, 20480
    v_lshlrev_b32 v224, 3, v252
    buffer_store_dwordx2 v[228:229], v224, s[8:11], s61 offen sc1
.Lwo_done:
    v_exp_f32 v0, v0
    v_exp_f32 v1, v1
    s_waitcnt lgkmcnt(1)
    ds_read_b64_tr_b16 v[134:135], v142 offset:128
    v_exp_f32 v2, v2
    v_exp_f32 v3, v3
    v_exp_f32 v4, v4
    v_mfma_f32_32x32x4_2b_bf16 v[32:63], v[116:117], v[106:107], 0
    s_cmp_lt_u32 s3, 4
    s_cbranch_scc0 .Lpr7
    s_setprio 2
.Lpr7:
    buffer_load_dwordx4 v119, s[8:11], s53 offen offset:2048 sc1 lds
    v_exp_f32 v5, v5
    v_exp_f32 v6, v6
    v_exp_f32 v7, v7
    v_exp_f32 v8, v8
    v_exp_f32 v9, v9
    v_exp_f32 v10, v10
    v_exp_f32 v11, v11
    v_exp_f32 v12, v12
    v_smfmac_f32_32x32x32_bf16 v[64:79], v[124:127], v[0:7], v118
    ds_read_b32 v116, v120 offset:4864
    v_exp_f32 v13, v13
    v_exp_f32 v14, v14
    v_exp_f32 v15, v15
    v_exp_f32 v16, v16
    v_exp_f32 v17, v17
    v_smfmac_f32_32x32x32_bf16 v[64:79], v[128:131], v[8:15], v118
    s_waitcnt lgkmcnt(1)
    ds_read_b64_tr_b16 v[136:137], v143 offset:0
    v_exp_f32 v18, v18
    v_exp_f32 v19, v19
    v_exp_f32 v20, v20
    v_mfma_f32_32x32x16_bf16 v[32:47], v[108:111], v[100:103], v[32:47]
    ds_read_b64_tr_b16 v[138:139], v143 offset:128
    v_exp_f32 v21, v21
    v_exp_f32 v22, v22
    v_exp_f32 v23, v23
    v_mfma_f32_32x32x16_bf16 v[48:63], v[112:115], v[100:103], v[48:63]
    ds_read_b128 v[108:111], v119 offset:4864
    v_exp_f32 v24, v24
    v_exp_f32 v25, v25
    v_exp_f32 v26, v26
    v_smfmac_f32_32x32x32_bf16 v[64:79], v[132:135], v[16:23], v118
    s_waitcnt lgkmcnt(1)
    ds_read_b128 v[112:115], v119 offset:5888
    v_exp_f32 v27, v27
    v_exp_f32 v28, v28
    v_exp_f32 v29, v29
    v_exp_f32 v30, v30
    v_exp_f32 v31, v31
    v_exp_f32 v32, v32
    v_exp_f32 v33, v33
    v_smfmac_f32_32x32x32_bf16 v[64:79], v[136:139], v[24:31], v118
    buffer_load_dwordx4 v119, s[8:11], s53 offen offset:3072 sc1 lds
    s_add_u32 m0, m0, 32768
    s_add_u32 s53, s53, 32768
    buffer_load_dwordx4 v119, s[8:11], s53 offen offset:0 sc1 lds
    v_exp_f32 v34, v34
    v_exp_f32 v35, v35
    v_exp_f32 v36, v36
    v_mfma_f32_32x32x4_2b_bf16 v[0:31], v[116:117], v[104:105], 0
    buffer_load_dwordx4 v119, s[8:11], s53 offen offset:1024 sc1 lds
    v_exp_f32 v37, v37
    v_exp_f32 v38, v38
    v_exp_f32 v39, v39
    v_exp_f32 v40, v40
    v_exp_f32 v41, v41
    v_exp_f32 v42, v42
    v_exp_f32 v43, v43
    v_exp_f32 v44, v44
    v_smfmac_f32_32x32x32_bf16 v[80:95], v[124:127], v[32:39], v118
    ds_read_b64_tr_b16 v[124:125], v140 offset:4864
    v_exp_f32 v45, v45
    v_exp_f32 v46, v46
    v_exp_f32 v47, v47
    v_exp_f32 v48, v48
    v_exp_f32 v49, v49
    v_smfmac_f32_32x32x32_bf16 v[80:95], v[128:131], v[40:47], v118
    s_waitcnt lgkmcnt(1)
    ds_read_b64_tr_b16 v[126:127], v140 offset:4992
    v_exp_f32 v50, v50
    v_exp_f32 v51, v51
    v_exp_f32 v52, v52
    v_mfma_f32_32x32x16_bf16 v[0:15], v[108:111], v[96:99], v[0:15]
    ds_read_b64_tr_b16 v[128:129], v141 offset:4864
    v_exp_f32 v53, v53
    v_exp_f32 v54, v54
    v_exp_f32 v55, v55
    v_mfma_f32_32x32x16_bf16 v[16:31], v[112:115], v[96:99], v[16:31]
    ds_read_b64_tr_b16 v[130:131], v141 offset:4992
    v_exp_f32 v56, v56
    v_exp_f32 v57, v57
    v_exp_f32 v58, v58
    v_smfmac_f32_32x32x32_bf16 v[80:95], v[132:135], v[48:55], v118
    ds_read_b64_tr_b16 v[132:133], v142 offset:4864
    v_exp_f32 v59, v59
    v_exp_f32 v60, v60
    v_exp_f32 v61, v61
    v_exp_f32 v62, v62
    v_exp_f32 v63, v63
    v_exp_f32 v0, v0
    v_exp_f32 v1, v1
    v_smfmac_f32_32x32x32_bf16 v[80:95], v[136:139], v[56:63], v118
    s_waitcnt lgkmcnt(1)
    ds_read_b64_tr_b16 v[134:135], v142 offset:4992
    v_exp_f32 v2, v2
    v_exp_f32 v3, v3
    v_exp_f32 v4, v4
    v_mfma_f32_32x32x4_2b_bf16 v[32:63], v[116:117], v[106:107], 0
    buffer_load_dwordx4 v119, s[8:11], s53 offen offset:2048 sc1 lds
    v_exp_f32 v5, v5
    v_exp_f32 v6, v6
    v_exp_f32 v7, v7
    v_exp_f32 v8, v8
    v_exp_f32 v9, v9
    v_exp_f32 v10, v10
    v_exp_f32 v11, v11
    v_exp_f32 v12, v12
    v_smfmac_f32_32x32x32_bf16 v[64:79], v[124:127], v[0:7], v118
    ds_read_b32 v116, v120 offset:9728
    v_exp_f32 v13, v13
    v_exp_f32 v14, v14
    v_exp_f32 v15, v15
    v_exp_f32 v16, v16
    v_exp_f32 v17, v17
    v_smfmac_f32_32x32x32_bf16 v[64:79], v[128:131], v[8:15], v118
    s_waitcnt lgkmcnt(1)
    ds_read_b64_tr_b16 v[136:137], v143 offset:4864
    v_exp_f32 v18, v18
    v_exp_f32 v19, v19
    v_exp_f32 v20, v20
    v_mfma_f32_32x32x16_bf16 v[32:47], v[108:111], v[100:103], v[32:47]
    ds_read_b64_tr_b16 v[138:139], v143 offset:4992
    v_exp_f32 v21, v21
    v_exp_f32 v22, v22
    v_exp_f32 v23, v23
    v_mfma_f32_32x32x16_bf16 v[48:63], v[112:115], v[100:103], v[48:63]
    ds_read_b128 v[108:111], v119 offset:9728
    v_exp_f32 v24, v24
    v_exp_f32 v25, v25
    v_exp_f32 v26, v26
    v_smfmac_f32_32x32x32_bf16 v[64:79], v[132:135], v[16:23], v118
    s_waitcnt lgkmcnt(1)
    ds_read_b128 v[112:115], v119 offset:10752
    v_exp_f32 v27, v27
    v_exp_f32 v28, v28
    v_exp_f32 v29, v29
    v_exp_f32 v30, v30
    v_exp_f32 v31, v31
    v_exp_f32 v32, v32
    v_exp_f32 v33, v33
    v_smfmac_f32_32x32x32_bf16 v[64:79], v[136:139], v[24:31], v118
    buffer_load_dwordx4 v119, s[8:11], s53 offen offset:3072 sc1 lds
    s_add_u32 m0, m0, 32768
    s_add_u32 s53, s53, 32768
    buffer_load_dwordx4 v119, s[8:11], s53 offen offset:0 sc1 lds
    v_exp_f32 v34, v34
    v_exp_f32 v35, v35
    v_exp_f32 v36, v36
    v_mfma_f32_32x32x4_2b_bf16 v[0:31], v[116:117], v[104:105], 0
    buffer_load_dwordx4 v119, s[8:11], s53 offen offset:1024 sc1 lds
    v_exp_f32 v37, v37
    v_exp_f32 v38, v38
    v_exp_f32 v39, v39
    v_exp_f32 v40, v40
    v_exp_f32 v41, v41
    v_exp_f32 v42, v42
    v_exp_f32 v43, v43
    v_exp_f32 v44, v44
    v_smfmac_f32_32x32x32_bf16 v[80:95], v[124:127], v[32:39], v118
    ds_read_b64_tr_b16 v[124:125], v140 offset:9728
    v_exp_f32 v45, v45
    v_exp_f32 v46, v46
    v_exp_f32 v47, v47
    v_exp_f32 v48, v48
    v_exp_f32 v49, v49
    v_smfmac_f32_32x32x32_bf16 v[80:95], v[128:131], v[40:47], v118
    s_waitcnt lgkmcnt(1)
    ds_read_b64_tr_b16 v[126:127], v140 offset:9856
    v_exp_f32 v50, v50
    v_exp_f32 v51, v51
    v_exp_f32 v52, v52
    v_mfma_f32_32x32x16_bf16 v[0:15], v[108:111], v[96:99], v[0:15]
    ds_read_b64_tr_b16 v[128:129], v141 offset:9728
    v_exp_f32 v53, v53
    v_exp_f32 v54, v54
    v_exp_f32 v55, v55
    v_mfma_f32_32x32x16_bf16 v[16:31], v[112:115], v[96:99], v[16:31]
    ds_read_b64_tr_b16 v[130:131], v141 offset:9856
    v_exp_f32 v56, v56
    v_exp_f32 v57, v57
    v_exp_f32 v58, v58
    v_smfmac_f32_32x32x32_bf16 v[80:95], v[132:135], v[48:55], v118
    ds_read_b64_tr_b16 v[132:133], v142 offset:9728
    v_exp_f32 v59, v59
    v_exp_f32 v60, v60
    v_exp_f32 v61, v61
    v_exp_f32 v62, v62
    v_exp_f32 v63, v63
    s_waitcnt vmcnt(6)
    s_barrier
    s_cmp_eq_u32 s3, 4
    s_cbranch_scc0 .Lnofw
    s_lshl_b32 s59, s2, 2
    s_add_u32 s59, s59, 14699520
    s_mov_b64 exec, 1
    buffer_store_dword v118, v254, s[8:11], s59 offen sc1
    s_mov_b64 exec, -1
.Lnofw:
    v_exp_f32 v0, v0
    v_exp_f32 v1, v1
    v_smfmac_f32_32x32x32_bf16 v[80:95], v[136:139], v[56:63], v118
    s_waitcnt lgkmcnt(1)
    ds_read_b64_tr_b16 v[134:135], v142 offset:9856
    v_exp_f32 v2, v2
    v_exp_f32 v3, v3
    v_exp_f32 v4, v4
    v_mfma_f32_32x32x4_2b_bf16 v[32:63], v[116:117], v[106:107], 0
    buffer_load_dwordx4 v119, s[8:11], s53 offen offset:2048 sc1 lds
    v_exp_f32 v5, v5
    v_exp_f32 v6, v6
    v_exp_f32 v7, v7
    v_exp_f32 v8, v8
    v_exp_f32 v9, v9
    v_exp_f32 v10, v10
    v_exp_f32 v11, v11
    v_exp_f32 v12, v12
    v_smfmac_f32_32x32x32_bf16 v[64:79], v[124:127], v[0:7], v118
    ds_read_b32 v116, v120 offset:14592
    v_exp_f32 v13, v13
    v_exp_f32 v14, v14
    v_exp_f32 v15, v15
    v_exp_f32 v16, v16
    v_exp_f32 v17, v17
    v_smfmac_f32_32x32x32_bf16 v[64:79], v[128:131], v[8:15], v118
    s_waitcnt lgkmcnt(1)
    ds_read_b64_tr_b16 v[136:137], v143 offset:9728
    v_exp_f32 v18, v18
    v_exp_f32 v19, v19
    v_exp_f32 v20, v20
    v_mfma_f32_32x32x16_bf16 v[32:47], v[108:111], v[100:103], v[32:47]
    ds_read_b64_tr_b16 v[138:139], v143 offset:9856
    v_exp_f32 v21, v21
    v_exp_f32 v22, v22
    v_exp_f32 v23, v23
    v_mfma_f32_32x32x16_bf16 v[48:63], v[112:115], v[100:103], v[48:63]
    ds_read_b128 v[108:111], v119 offset:14592
    v_exp_f32 v24, v24
    v_exp_f32 v25, v25
    v_exp_f32 v26, v26
    v_smfmac_f32_32x32x32_bf16 v[64:79], v[132:135], v[16:23], v118
    s_waitcnt lgkmcnt(1)
    ds_read_b128 v[112:115], v119 offset:15616
    v_exp_f32 v27, v27
    v_exp_f32 v28, v28
    v_exp_f32 v29, v29
    v_exp_f32 v30, v30
    v_exp_f32 v31, v31
    v_exp_f32 v32, v32
    v_exp_f32 v33, v33
    v_smfmac_f32_32x32x32_bf16 v[64:79], v[136:139], v[24:31], v118
    buffer_load_dwordx4 v119, s[8:11], s53 offen offset:3072 sc1 lds
    s_add_u32 m0, m0, 32768
    s_add_u32 s53, s53, 32768
    buffer_load_dwordx4 v119, s[8:11], s53 offen offset:0 sc1 lds
    v_exp_f32 v34, v34
    v_exp_f32 v35, v35
    v_exp_f32 v36, v36
    v_mfma_f32_32x32x4_2b_bf16 v[0:31], v[116:117], v[104:105], 0
    buffer_load_dwordx4 v119, s[8:11], s53 offen offset:1024 sc1 lds
    v_exp_f32 v37, v37
    v_exp_f32 v38, v38
    v_exp_f32 v39, v39
    v_exp_f32 v40, v40
    v_exp_f32 v41, v41
    v_exp_f32 v42, v42
    v_exp_f32 v43, v43
    v_exp_f32 v44, v44
    v_smfmac_f32_32x32x32_bf16 v[80:95], v[124:127], v[32:39], v118
    ds_read_b64_tr_b16 v[124:125], v140 offset:14592
    v_exp_f32 v45, v45
    v_exp_f32 v46, v46
    v_exp_f32 v47, v47
    v_exp_f32 v48, v48
    v_exp_f32 v49, v49
    v_smfmac_f32_32x32x32_bf16 v[80:95], v[128:131], v[40:47], v118
    s_waitcnt lgkmcnt(1)
    ds_read_b64_tr_b16 v[126:127], v140 offset:14720
    v_exp_f32 v50, v50
    v_exp_f32 v51, v51
    v_exp_f32 v52, v52
    v_mfma_f32_32x32x16_bf16 v[0:15], v[108:111], v[96:99], v[0:15]
    ds_read_b64_tr_b16 v[128:129], v141 offset:14592
    v_exp_f32 v53, v53
    v_exp_f32 v54, v54
    v_exp_f32 v55, v55
    v_mfma_f32_32x32x16_bf16 v[16:31], v[112:115], v[96:99], v[16:31]
    ds_read_b64_tr_b16 v[130:131], v141 offset:14720
    v_exp_f32 v56, v56
    v_exp_f32 v57, v57
    v_exp_f32 v58, v58
    v_smfmac_f32_32x32x32_bf16 v[80:95], v[132:135], v[48:55], v118
    ds_read_b64_tr_b16 v[132:133], v142 offset:14592
    v_exp_f32 v59, v59
    v_exp_f32 v60, v60
    v_exp_f32 v61, v61
    v_exp_f32 v62, v62
    v_exp_f32 v63, v63
    v_exp_f32 v0, v0
    v_exp_f32 v1, v1
    v_smfmac_f32_32x32x32_bf16 v[80:95], v[136:139], v[56:63], v118
    s_waitcnt lgkmcnt(1)
    ds_read_b64_tr_b16 v[134:135], v142 offset:14720
    v_exp_f32 v2, v2
    v_exp_f32 v3, v3
    v_exp_f32 v4, v4
    v_mfma_f32_32x32x4_2b_bf16 v[32:63], v[116:117], v[106:107], 0
    buffer_load_dwordx4 v119, s[8:11], s53 offen offset:2048 sc1 lds
    v_exp_f32 v5, v5
    v_exp_f32 v6, v6
    v_exp_f32 v7, v7
    v_exp_f32 v8, v8
    v_exp_f32 v9, v9
    v_exp_f32 v10, v10
    v_exp_f32 v11, v11
    v_exp_f32 v12, v12
    v_smfmac_f32_32x32x32_bf16 v[64:79], v[124:127], v[0:7], v118
    ds_read_b32 v116, v120 offset:19456
    v_exp_f32 v13, v13
    v_exp_f32 v14, v14
    v_exp_f32 v15, v15
    v_exp_f32 v16, v16
    v_exp_f32 v17, v17
    v_smfmac_f32_32x32x32_bf16 v[64:79], v[128:131], v[8:15], v118
    s_waitcnt lgkmcnt(1)
    ds_read_b64_tr_b16 v[136:137], v143 offset:14592
    v_exp_f32 v18, v18
    v_exp_f32 v19, v19
    v_exp_f32 v20, v20
    v_mfma_f32_32x32x16_bf16 v[32:47], v[108:111], v[100:103], v[32:47]
    ds_read_b64_tr_b16 v[138:139], v143 offset:14720
    v_exp_f32 v21, v21
    v_exp_f32 v22, v22
    v_exp_f32 v23, v23
    v_mfma_f32_32x32x16_bf16 v[48:63], v[112:115], v[100:103], v[48:63]
    ds_read_b128 v[108:111], v119 offset:19456
    v_exp_f32 v24, v24
    v_exp_f32 v25, v25
    v_exp_f32 v26, v26
    v_smfmac_f32_32x32x32_bf16 v[64:79], v[132:135], v[16:23], v118
    s_waitcnt lgkmcnt(1)
    ds_read_b128 v[112:115], v119 offset:20480
    v_exp_f32 v27, v27
    v_exp_f32 v28, v28
    v_exp_f32 v29, v29
    v_exp_f32 v30, v30
    v_exp_f32 v31, v31
    v_exp_f32 v32, v32
    v_exp_f32 v33, v33
    v_smfmac_f32_32x32x32_bf16 v[64:79], v[136:139], v[24:31], v118
    buffer_load_dwordx4 v119, s[8:11], s53 offen offset:3072 sc1 lds
    v_exp_f32 v34, v34
    v_exp_f32 v35, v35
    v_exp_f32 v36, v36
    v_mfma_f32_32x32x4_2b_bf16 v[0:31], v[116:117], v[104:105], 0
    v_exp_f32 v37, v37
    v_exp_f32 v38, v38
    v_exp_f32 v39, v39
    v_exp_f32 v40, v40
    v_exp_f32 v41, v41
    v_exp_f32 v42, v42
    v_exp_f32 v43, v43
    v_exp_f32 v44, v44
    v_smfmac_f32_32x32x32_bf16 v[80:95], v[124:127], v[32:39], v118
    ds_read_b64_tr_b16 v[124:125], v140 offset:19456
    v_exp_f32 v45, v45
    v_exp_f32 v46, v46
    v_exp_f32 v47, v47
    v_exp_f32 v48, v48
    v_exp_f32 v49, v49
    v_smfmac_f32_32x32x32_bf16 v[80:95], v[128:131], v[40:47], v118
    s_waitcnt lgkmcnt(1)
    ds_read_b64_tr_b16 v[126:127], v140 offset:19584
    v_exp_f32 v50, v50
    v_exp_f32 v51, v51
    v_exp_f32 v52, v52
    v_mfma_f32_32x32x16_bf16 v[0:15], v[108:111], v[96:99], v[0:15]
    ds_read_b64_tr_b16 v[128:129], v141 offset:19456
    v_exp_f32 v53, v53
    v_exp_f32 v54, v54
    v_exp_f32 v55, v55
    v_mfma_f32_32x32x16_bf16 v[16:31], v[112:115], v[96:99], v[16:31]
    ds_read_b64_tr_b16 v[130:131], v141 offset:19584
    v_exp_f32 v56, v56
    v_exp_f32 v57, v57
    v_exp_f32 v58, v58
    v_smfmac_f32_32x32x32_bf16 v[80:95], v[132:135], v[48:55], v118
    ds_read_b64_tr_b16 v[132:133], v142 offset:19456
    v_exp_f32 v59, v59
    v_exp_f32 v60, v60
    v_exp_f32 v61, v61
    v_exp_f32 v62, v62
    v_exp_f32 v63, v63
    v_exp_f32 v0, v0
    v_exp_f32 v1, v1
    v_smfmac_f32_32x32x32_bf16 v[80:95], v[136:139], v[56:63], v118
    s_waitcnt lgkmcnt(1)
    ds_read_b64_tr_b16 v[134:135], v142 offset:19584
    v_exp_f32 v2, v2
    v_exp_f32 v3, v3
    v_exp_f32 v4, v4
    v_mfma_f32_32x32x4_2b_bf16 v[32:63], v[116:117], v[106:107], 0
    v_exp_f32 v5, v5
    v_exp_f32 v6, v6
    v_exp_f32 v7, v7
    v_exp_f32 v8, v8
    v_exp_f32 v9, v9
    v_exp_f32 v10, v10
    v_exp_f32 v11, v11
    v_exp_f32 v12, v12
    v_smfmac_f32_32x32x32_bf16 v[64:79], v[124:127], v[0:7], v118
    ds_read_b32 v116, v120 offset:24320
    v_exp_f32 v13, v13
    v_exp_f32 v14, v14
    v_exp_f32 v15, v15
    v_exp_f32 v16, v16
    v_exp_f32 v17, v17
    v_smfmac_f32_32x32x32_bf16 v[64:79], v[128:131], v[8:15], v118
    s_waitcnt lgkmcnt(1)
    ds_read_b64_tr_b16 v[136:137], v143 offset:19456
    v_exp_f32 v18, v18
    v_exp_f32 v19, v19
    v_exp_f32 v20, v20
    v_mfma_f32_32x32x16_bf16 v[32:47], v[108:111], v[100:103], v[32:47]
    ds_read_b64_tr_b16 v[138:139], v143 offset:19584
    v_exp_f32 v21, v21
    v_exp_f32 v22, v22
    v_exp_f32 v23, v23
    v_mfma_f32_32x32x16_bf16 v[48:63], v[112:115], v[100:103], v[48:63]
    ds_read_b128 v[108:111], v119 offset:24320
    v_exp_f32 v24, v24
    v_exp_f32 v25, v25
    v_exp_f32 v26, v26
    v_smfmac_f32_32x32x32_bf16 v[64:79], v[132:135], v[16:23], v118
    s_waitcnt lgkmcnt(1)
    ds_read_b128 v[112:115], v119 offset:25344
    v_exp_f32 v27, v27
    v_exp_f32 v28, v28
    v_exp_f32 v29, v29
    v_exp_f32 v30, v30
    v_exp_f32 v31, v31
    v_exp_f32 v32, v32
    v_exp_f32 v33, v33
    v_smfmac_f32_32x32x32_bf16 v[64:79], v[136:139], v[24:31], v118
    v_exp_f32 v34, v34
    v_exp_f32 v35, v35
    v_exp_f32 v36, v36
    v_mfma_f32_32x32x4_2b_bf16 v[0:31], v[116:117], v[104:105], 0
    v_exp_f32 v37, v37
    v_exp_f32 v38, v38
    v_exp_f32 v39, v39
    v_exp_f32 v40, v40
    v_exp_f32 v41, v41
    v_exp_f32 v42, v42
    v_exp_f32 v43, v43
    v_exp_f32 v44, v44
    v_smfmac_f32_32x32x32_bf16 v[80:95], v[124:127], v[32:39], v118
    ds_read_b64_tr_b16 v[124:125], v140 offset:24320
    v_exp_f32 v45, v45
    v_exp_f32 v46, v46
    v_exp_f32 v47, v47
    v_exp_f32 v48, v48
    v_exp_f32 v49, v49
    v_smfmac_f32_32x32x32_bf16 v[80:95], v[128:131], v[40:47], v118
    s_waitcnt lgkmcnt(1)
    ds_read_b64_tr_b16 v[126:127], v140 offset:24448
    v_exp_f32 v50, v50
    v_exp_f32 v51, v51
    v_exp_f32 v52, v52
    v_mfma_f32_32x32x16_bf16 v[0:15], v[108:111], v[96:99], v[0:15]
    ds_read_b64_tr_b16 v[128:129], v141 offset:24320
    v_exp_f32 v53, v53
    v_exp_f32 v54, v54
    v_exp_f32 v55, v55
    v_mfma_f32_32x32x16_bf16 v[16:31], v[112:115], v[96:99], v[16:31]
    ds_read_b64_tr_b16 v[130:131], v141 offset:24448
    v_exp_f32 v56, v56
    v_exp_f32 v57, v57
    v_exp_f32 v58, v58
    v_smfmac_f32_32x32x32_bf16 v[80:95], v[132:135], v[48:55], v118
    ds_read_b64_tr_b16 v[132:133], v142 offset:24320
    v_exp_f32 v59, v59
    v_exp_f32 v60, v60
    v_exp_f32 v61, v61
    v_exp_f32 v62, v62
    v_exp_f32 v63, v63
    v_exp_f32 v0, v0
    v_exp_f32 v1, v1
    v_smfmac_f32_32x32x32_bf16 v[80:95], v[136:139], v[56:63], v118
    s_waitcnt lgkmcnt(1)
    ds_read_b64_tr_b16 v[134:135], v142 offset:24448
    v_exp_f32 v2, v2
    v_exp_f32 v3, v3
    v_exp_f32 v4, v4
    v_mfma_f32_32x32x4_2b_bf16 v[32:63], v[116:117], v[106:107], 0
    v_exp_f32 v5, v5
    v_exp_f32 v6, v6
    v_exp_f32 v7, v7
    v_exp_f32 v8, v8
    v_exp_f32 v9, v9
    v_exp_f32 v10, v10
    v_exp_f32 v11, v11
    v_exp_f32 v12, v12
    v_smfmac_f32_32x32x32_bf16 v[64:79], v[124:127], v[0:7], v118
    ds_read_b32 v116, v120 offset:29184
    v_exp_f32 v13, v13
    v_exp_f32 v14, v14
    v_exp_f32 v15, v15
    v_exp_f32 v16, v16
    v_exp_f32 v17, v17
    v_smfmac_f32_32x32x32_bf16 v[64:79], v[128:131], v[8:15], v118
    s_waitcnt lgkmcnt(1)
    ds_read_b64_tr_b16 v[136:137], v143 offset:24320
    v_exp_f32 v18, v18
    v_exp_f32 v19, v19
    v_exp_f32 v20, v20
    v_mfma_f32_32x32x16_bf16 v[32:47], v[108:111], v[100:103], v[32:47]
    ds_read_b64_tr_b16 v[138:139], v143 offset:24448
    v_exp_f32 v21, v21
    v_exp_f32 v22, v22
    v_exp_f32 v23, v23
    v_mfma_f32_32x32x16_bf16 v[48:63], v[112:115], v[100:103], v[48:63]
    ds_read_b128 v[108:111], v119 offset:29184
    v_exp_f32 v24, v24
    v_exp_f32 v25, v25
    v_exp_f32 v26, v26
    v_smfmac_f32_32x32x32_bf16 v[64:79], v[132:135], v[16:23], v118
    s_waitcnt lgkmcnt(1)
    ds_read_b128 v[112:115], v119 offset:30208
    v_exp_f32 v27, v27
    v_exp_f32 v28, v28
    v_exp_f32 v29, v29
    v_exp_f32 v30, v30
    v_exp_f32 v31, v31
    v_exp_f32 v32, v32
    v_exp_f32 v33, v33
    v_smfmac_f32_32x32x32_bf16 v[64:79], v[136:139], v[24:31], v118
    v_exp_f32 v34, v34
    v_exp_f32 v35, v35
    v_exp_f32 v36, v36
    v_mfma_f32_32x32x4_2b_bf16 v[0:31], v[116:117], v[104:105], 0
    v_exp_f32 v37, v37
    v_exp_f32 v38, v38
    v_exp_f32 v39, v39
    v_exp_f32 v40, v40
    v_exp_f32 v41, v41
    v_exp_f32 v42, v42
    v_exp_f32 v43, v43
    v_exp_f32 v44, v44
    v_smfmac_f32_32x32x32_bf16 v[80:95], v[124:127], v[32:39], v118
    ds_read_b64_tr_b16 v[124:125], v140 offset:29184
    v_exp_f32 v45, v45
    v_exp_f32 v46, v46
    v_exp_f32 v47, v47
    v_exp_f32 v48, v48
    v_exp_f32 v49, v49
    v_smfmac_f32_32x32x32_bf16 v[80:95], v[128:131], v[40:47], v118
    s_waitcnt lgkmcnt(1)
    ds_read_b64_tr_b16 v[126:127], v140 offset:29312
    v_exp_f32 v50, v50
    v_exp_f32 v51, v51
    v_exp_f32 v52, v52
    v_mfma_f32_32x32x16_bf16 v[0:15], v[108:111], v[96:99], v[0:15]
    ds_read_b64_tr_b16 v[128:129], v141 offset:29184
    v_exp_f32 v53, v53
    v_exp_f32 v54, v54
    v_exp_f32 v55, v55
    v_mfma_f32_32x32x16_bf16 v[16:31], v[112:115], v[96:99], v[16:31]
    ds_read_b64_tr_b16 v[130:131], v141 offset:29312
    v_exp_f32 v56, v56
    v_exp_f32 v57, v57
    v_exp_f32 v58, v58
    v_smfmac_f32_32x32x32_bf16 v[80:95], v[132:135], v[48:55], v118
    ds_read_b64_tr_b16 v[132:133], v142 offset:29184
    v_exp_f32 v59, v59
    v_exp_f32 v60, v60
    v_exp_f32 v61, v61
    v_exp_f32 v62, v62
    v_exp_f32 v63, v63
    v_exp_f32 v0, v0
    v_exp_f32 v1, v1
    v_smfmac_f32_32x32x32_bf16 v[80:95], v[136:139], v[56:63], v118
    s_waitcnt lgkmcnt(1)
    ds_read_b64_tr_b16 v[134:135], v142 offset:29312
    v_exp_f32 v2, v2
    v_exp_f32 v3, v3
    v_exp_f32 v4, v4
    v_mfma_f32_32x32x4_2b_bf16 v[32:63], v[116:117], v[106:107], 0
    v_exp_f32 v5, v5
    v_exp_f32 v6, v6
    v_exp_f32 v7, v7
    v_exp_f32 v8, v8
    v_exp_f32 v9, v9
    v_exp_f32 v10, v10
    v_exp_f32 v11, v11
    v_exp_f32 v12, v12
    v_smfmac_f32_32x32x32_bf16 v[64:79], v[124:127], v[0:7], v118
    ds_read_b32 v116, v120 offset:34048
    v_exp_f32 v13, v13
    v_exp_f32 v14, v14
    v_exp_f32 v15, v15
    v_exp_f32 v16, v16
    v_exp_f32 v17, v17
    v_smfmac_f32_32x32x32_bf16 v[64:79], v[128:131], v[8:15], v118
    s_waitcnt lgkmcnt(1)
    ds_read_b64_tr_b16 v[136:137], v143 offset:29184
    v_exp_f32 v18, v18
    v_exp_f32 v19, v19
    v_exp_f32 v20, v20
    v_mfma_f32_32x32x16_bf16 v[32:47], v[108:111], v[100:103], v[32:47]
    ds_read_b64_tr_b16 v[138:139], v143 offset:29312
    v_exp_f32 v21, v21
    v_exp_f32 v22, v22
    v_exp_f32 v23, v23
    v_mfma_f32_32x32x16_bf16 v[48:63], v[112:115], v[100:103], v[48:63]
    ds_read_b128 v[108:111], v119 offset:34048
    v_exp_f32 v24, v24
    v_exp_f32 v25, v25
    v_exp_f32 v26, v26
    v_smfmac_f32_32x32x32_bf16 v[64:79], v[132:135], v[16:23], v118
    s_waitcnt lgkmcnt(1)
    ds_read_b128 v[112:115], v119 offset:35072
    v_exp_f32 v27, v27
    v_exp_f32 v28, v28
    v_exp_f32 v29, v29
    v_exp_f32 v30, v30
    v_exp_f32 v31, v31
    v_exp_f32 v32, v32
    v_exp_f32 v33, v33
    v_smfmac_f32_32x32x32_bf16 v[64:79], v[136:139], v[24:31], v118
    v_exp_f32 v34, v34
    v_exp_f32 v35, v35
    v_exp_f32 v36, v36
    v_mfma_f32_32x32x4_2b_bf16 v[0:31], v[116:117], v[104:105], 0
    v_exp_f32 v37, v37
    v_exp_f32 v38, v38
    v_exp_f32 v39, v39
    v_exp_f32 v40, v40
    v_exp_f32 v41, v41
    v_exp_f32 v42, v42
    v_exp_f32 v43, v43
    v_exp_f32 v44, v44
    v_smfmac_f32_32x32x32_bf16 v[80:95], v[124:127], v[32:39], v118
    ds_read_b64_tr_b16 v[124:125], v140 offset:34048
    v_exp_f32 v45, v45
    v_exp_f32 v46, v46
    v_exp_f32 v47, v47
    v_exp_f32 v48, v48
    v_exp_f32 v49, v49
    v_smfmac_f32_32x32x32_bf16 v[80:95], v[128:131], v[40:47], v118
    s_waitcnt lgkmcnt(1)
    ds_read_b64_tr_b16 v[126:127], v140 offset:34176
    v_exp_f32 v50, v50
    v_exp_f32 v51, v51
    v_exp_f32 v52, v52
    v_mfma_f32_32x32x16_bf16 v[0:15], v[108:111], v[96:99], v[0:15]
    ds_read_b64_tr_b16 v[128:129], v141 offset:34048
    v_exp_f32 v53, v53
    v_exp_f32 v54, v54
    v_exp_f32 v55, v55
    v_mfma_f32_32x32x16_bf16 v[16:31], v[112:115], v[96:99], v[16:31]
    ds_read_b64_tr_b16 v[130:131], v141 offset:34176
    v_exp_f32 v56, v56
    v_exp_f32 v57, v57
    v_exp_f32 v58, v58
    v_smfmac_f32_32x32x32_bf16 v[80:95], v[132:135], v[48:55], v118
    ds_read_b64_tr_b16 v[132:133], v142 offset:34048
    v_exp_f32 v59, v59
    v_exp_f32 v60, v60
    v_exp_f32 v61, v61
    v_exp_f32 v62, v62
    v_exp_f32 v63, v63
    s_waitcnt vmcnt(0)
    s_barrier
    buffer_load_dword v255, v246, s[8:11], s57 offen sc1
    v_exp_f32 v0, v0
    v_exp_f32 v1, v1
    v_smfmac_f32_32x32x32_bf16 v[80:95], v[136:139], v[56:63], v118
    s_waitcnt lgkmcnt(1)
    ds_read_b64_tr_b16 v[134:135], v142 offset:34176
    v_exp_f32 v2, v2
    v_exp_f32 v3, v3
    v_exp_f32 v4, v4
    v_mfma_f32_32x32x4_2b_bf16 v[32:63], v[116:117], v[106:107], 0
    s_cmp_lt_u32 s3, 4
    s_cbranch_scc0 .Lpr8
    s_setprio 0
.Lpr8:
    v_exp_f32 v5, v5
    v_exp_f32 v6, v6
    v_exp_f32 v7, v7
    v_exp_f32 v8, v8
    v_exp_f32 v9, v9
    v_exp_f32 v10, v10
    v_exp_f32 v11, v11
    v_exp_f32 v12, v12
    v_smfmac_f32_32x32x32_bf16 v[64:79], v[124:127], v[0:7], v118
    ds_read_b32 v116, v120 offset:38912
    v_exp_f32 v13, v13
    v_exp_f32 v14, v14
    v_exp_f32 v15, v15
    v_exp_f32 v16, v16
    v_exp_f32 v17, v17
    v_smfmac_f32_32x32x32_bf16 v[64:79], v[128:131], v[8:15], v118
    s_waitcnt lgkmcnt(1)
    ds_read_b64_tr_b16 v[136:137], v143 offset:34048
    v_exp_f32 v18, v18
    v_exp_f32 v19, v19
    v_exp_f32 v20, v20
    v_mfma_f32_32x32x16_bf16 v[32:47], v[108:111], v[100:103], v[32:47]
    ds_read_b64_tr_b16 v[138:139], v143 offset:34176
    v_exp_f32 v21, v21
    v_exp_f32 v22, v22
    v_exp_f32 v23, v23
    v_mfma_f32_32x32x16_bf16 v[48:63], v[112:115], v[100:103], v[48:63]
    ds_read_b128 v[108:111], v119 offset:38912
    v_exp_f32 v24, v24
    v_exp_f32 v25, v25
    v_exp_f32 v26, v26
    v_smfmac_f32_32x32x32_bf16 v[64:79], v[132:135], v[16:23], v118
    s_waitcnt lgkmcnt(1)
    ds_read_b128 v[112:115], v119 offset:39936
    v_exp_f32 v27, v27
    v_exp_f32 v28, v28
    v_exp_f32 v29, v29
    v_exp_f32 v30, v30
    v_exp_f32 v31, v31
    v_exp_f32 v32, v32
    v_exp_f32 v33, v33
    v_smfmac_f32_32x32x32_bf16 v[64:79], v[136:139], v[24:31], v118
    v_exp_f32 v34, v34
    v_exp_f32 v35, v35
    v_exp_f32 v36, v36
    v_mfma_f32_32x32x4_2b_bf16 v[0:31], v[116:117], v[104:105], 0
    v_exp_f32 v37, v37
    v_exp_f32 v38, v38
    v_exp_f32 v39, v39
    v_exp_f32 v40, v40
    v_exp_f32 v41, v41
    v_exp_f32 v42, v42
    v_exp_f32 v43, v43
    v_exp_f32 v44, v44
    v_smfmac_f32_32x32x32_bf16 v[80:95], v[124:127], v[32:39], v118
    ds_read_b64_tr_b16 v[124:125], v140 offset:38912
    v_exp_f32 v45, v45
    v_exp_f32 v46, v46
    v_exp_f32 v47, v47
    v_exp_f32 v48, v48
    v_exp_f32 v49, v49
    v_smfmac_f32_32x32x32_bf16 v[80:95], v[128:131], v[40:47], v118
    s_waitcnt lgkmcnt(1)
    ds_read_b64_tr_b16 v[126:127], v140 offset:39040
    v_exp_f32 v50, v50
    v_exp_f32 v51, v51
    v_exp_f32 v52, v52
    v_mfma_f32_32x32x16_bf16 v[0:15], v[108:111], v[96:99], v[0:15]
    ds_read_b64_tr_b16 v[128:129], v141 offset:38912
    v_exp_f32 v53, v53
    v_exp_f32 v54, v54
    v_exp_f32 v55, v55
    v_mfma_f32_32x32x16_bf16 v[16:31], v[112:115], v[96:99], v[16:31]
    ds_read_b64_tr_b16 v[130:131], v141 offset:39040
    v_exp_f32 v56, v56
    v_exp_f32 v57, v57
    v_exp_f32 v58, v58
    v_smfmac_f32_32x32x32_bf16 v[80:95], v[132:135], v[48:55], v118
    ds_read_b64_tr_b16 v[132:133], v142 offset:38912
    v_exp_f32 v59, v59
    v_exp_f32 v60, v60
    v_exp_f32 v61, v61
    v_exp_f32 v62, v62
    v_exp_f32 v63, v63
    v_add_u32 v119, 38912, v119
    v_add_u32 v120, 38912, v120
    v_add_u32 v140, 38912, v140
    v_add_u32 v141, 38912, v141
    v_add_u32 v142, 38912, v142
    v_add_u32 v143, 38912, v143
    s_lshl_b32 s21, s49, 10
    s_and_b32 s22, s4, 4
    s_lshr_b32 s23, s5, 3
    s_add_u32 s22, s22, s23
    s_lshl_b32 s22, s22, 7
    s_and_b32 s23, s4, 3
    s_lshl_b32 s23, s23, 3
    s_add_u32 s22, s22, s23
    s_and_b32 s23, s5, 4
    s_add_u32 s22, s22, s23
    s_add_u32 s21, s21, s22
    s_add_u32 s21, s21, 14700544
    s_lshl_b32 s50, s4, 2
    s_and_b32 s51, s5, 3
    s_add_u32 s50, s50, s51
    s_lshr_b32 s51, s5, 2
    s_lshl_b32 s20, s50, 10
    s_lshl_b32 s22, s3, 7
    s_add_u32 s20, s20, s22
    s_add_u32 s20, s20, 14700544
    v_and_b32 v250, 7, v252
    v_lshlrev_b32 v250, 2, v250
    s_mov_b32 s70, 3000000
    s_mov_b32 s68, 0xfff
    s_mov_b32 s69, 0x0
    s_branch .Lpolll11
.Lpoll9:
    buffer_load_dword v255, v246, s[8:11], s57 offen sc1
.Lpolll11:
    s_waitcnt vmcnt(0)
    v_cmp_ne_u32 vcc, 0, v255
    s_and_b64 vcc, vcc, s[68:69]
    s_cmp_eq_u64 vcc, s[68:69]
    s_cbranch_scc1 .Lpolld10
    s_sub_u32 s70, s70, 1
    s_cmp_lg_u32 s70, 0
    s_cbranch_scc1 .Lpoll9
.Lpolld10:
    v_exp_f32 v0, v0
    v_exp_f32 v1, v1
    v_smfmac_f32_32x32x32_bf16 v[80:95], v[136:139], v[56:63], v118
    s_waitcnt lgkmcnt(1)
    ds_read_b64_tr_b16 v[134:135], v142 offset:128
    v_exp_f32 v2, v2
    v_exp_f32 v3, v3
    v_exp_f32 v4, v4
    v_mfma_f32_32x32x4_2b_bf16 v[32:63], v[116:117], v[106:107], 0
    s_cmp_lt_u32 s3, 4
    s_cbranch_scc0 .Lpr12
    s_setprio 2
.Lpr12:
    s_add_u32 s59, s4, 1
    s_and_b32 s59, s59, 3
    s_mul_i32 s59, s59, 5120
    s_add_u32 s26, s59, s24
    buffer_load_dwordx4 v[152:155], v148, s[8:11], s26 offen offset:0 sc1
    v_exp_f32 v5, v5
    v_exp_f32 v6, v6
    v_exp_f32 v7, v7
    v_exp_f32 v8, v8
    v_exp_f32 v9, v9
    v_exp_f32 v10, v10
    v_exp_f32 v11, v11
    v_exp_f32 v12, v12
    v_smfmac_f32_32x32x32_bf16 v[64:79], v[124:127], v[0:7], v118
    ds_read_b32 v116, v120 offset:4864
    v_exp_f32 v13, v13
    v_exp_f32 v14, v14
    v_exp_f32 v15, v15
    v_exp_f32 v16, v16
    v_exp_f32 v17, v17
    v_smfmac_f32_32x32x32_bf16 v[64:79], v[128:131], v[8:15], v118
    s_waitcnt lgkmcnt(1)
    ds_read_b64_tr_b16 v[136:137], v143 offset:0
    v_exp_f32 v18, v18
    v_exp_f32 v19, v19
    v_exp_f32 v20, v20
    v_mfma_f32_32x32x16_bf16 v[32:47], v[108:111], v[100:103], v[32:47]
    ds_read_b64_tr_b16 v[138:139], v143 offset:128
    v_exp_f32 v21, v21
    v_exp_f32 v22, v22
    v_exp_f32 v23, v23
    v_mfma_f32_32x32x16_bf16 v[48:63], v[112:115], v[100:103], v[48:63]
    ds_read_b128 v[108:111], v119 offset:4864
    v_exp_f32 v24, v24
    v_exp_f32 v25, v25
    v_exp_f32 v26, v26
    v_smfmac_f32_32x32x32_bf16 v[64:79], v[132:135], v[16:23], v118
    s_waitcnt lgkmcnt(1)
    ds_read_b128 v[112:115], v119 offset:5888
    v_exp_f32 v27, v27
    v_exp_f32 v28, v28
    v_exp_f32 v29, v29
    v_exp_f32 v30, v30
    v_exp_f32 v31, v31
    v_exp_f32 v32, v32
    v_exp_f32 v33, v33
    v_smfmac_f32_32x32x32_bf16 v[64:79], v[136:139], v[24:31], v118
    buffer_load_dwordx4 v[156:159], v148, s[8:11], s26 offen offset:1024 sc1
    buffer_load_dwordx4 v[160:163], v148, s[8:11], s26 offen offset:2048 sc1
    v_exp_f32 v34, v34
    v_exp_f32 v35, v35
    v_exp_f32 v36, v36
    v_mfma_f32_32x32x4_2b_bf16 v[0:31], v[116:117], v[104:105], 0
    buffer_load_dwordx4 v[164:167], v148, s[8:11], s26 offen offset:3072 sc1
    v_exp_f32 v37, v37
    v_exp_f32 v38, v38
    v_exp_f32 v39, v39
    v_exp_f32 v40, v40
    v_exp_f32 v41, v41
    v_exp_f32 v42, v42
    v_exp_f32 v43, v43
    v_exp_f32 v44, v44
    v_smfmac_f32_32x32x32_bf16 v[80:95], v[124:127], v[32:39], v118
    ds_read_b64_tr_b16 v[124:125], v140 offset:4864
    v_exp_f32 v45, v45
    v_exp_f32 v46, v46
    v_exp_f32 v47, v47
    v_exp_f32 v48, v48
    v_exp_f32 v49, v49
    v_smfmac_f32_32x32x32_bf16 v[80:95], v[128:131], v[40:47], v118
    s_waitcnt lgkmcnt(1)
    ds_read_b64_tr_b16 v[126:127], v140 offset:4992
    v_exp_f32 v50, v50
    v_exp_f32 v51, v51
    v_exp_f32 v52, v52
    v_mfma_f32_32x32x16_bf16 v[0:15], v[108:111], v[96:99], v[0:15]
    ds_read_b64_tr_b16 v[128:129], v141 offset:4864
    v_exp_f32 v53, v53
    v_exp_f32 v54, v54
    v_exp_f32 v55, v55
    v_mfma_f32_32x32x16_bf16 v[16:31], v[112:115], v[96:99], v[16:31]
    ds_read_b64_tr_b16 v[130:131], v141 offset:4992
    v_exp_f32 v56, v56
    v_exp_f32 v57, v57
    v_exp_f32 v58, v58
    v_smfmac_f32_32x32x32_bf16 v[80:95], v[132:135], v[48:55], v118
    ds_read_b64_tr_b16 v[132:133], v142 offset:4864
    v_exp_f32 v59, v59
    v_exp_f32 v60, v60
    v_exp_f32 v61, v61
    v_exp_f32 v62, v62
    v_exp_f32 v63, v63
    v_exp_f32 v0, v0
    v_exp_f32 v1, v1
    v_smfmac_f32_32x32x32_bf16 v[80:95], v[136:139], v[56:63], v118
    s_waitcnt lgkmcnt(1)
    ds_read_b64_tr_b16 v[134:135], v142 offset:4992
    v_exp_f32 v2, v2
    v_exp_f32 v3, v3
    v_exp_f32 v4, v4
    v_mfma_f32_32x32x4_2b_bf16 v[32:63], v[116:117], v[106:107], 0
    buffer_load_dwordx4 v[168:171], v151, s[8:11], s26 offen offset:0 sc1
    v_exp_f32 v5, v5
    v_exp_f32 v6, v6
    v_exp_f32 v7, v7
    v_exp_f32 v8, v8
    v_exp_f32 v9, v9
    v_exp_f32 v10, v10
    v_exp_f32 v11, v11
    v_exp_f32 v12, v12
    v_smfmac_f32_32x32x32_bf16 v[64:79], v[124:127], v[0:7], v118
    ds_read_b32 v116, v120 offset:9728
    v_exp_f32 v13, v13
    v_exp_f32 v14, v14
    v_exp_f32 v15, v15
    v_exp_f32 v16, v16
    v_exp_f32 v17, v17
    v_smfmac_f32_32x32x32_bf16 v[64:79], v[128:131], v[8:15], v118
    s_waitcnt lgkmcnt(1)
    ds_read_b64_tr_b16 v[136:137], v143 offset:4864
    v_exp_f32 v18, v18
    v_exp_f32 v19, v19
    v_exp_f32 v20, v20
    v_mfma_f32_32x32x16_bf16 v[32:47], v[108:111], v[100:103], v[32:47]
    ds_read_b64_tr_b16 v[138:139], v143 offset:4992
    v_exp_f32 v21, v21
    v_exp_f32 v22, v22
    v_exp_f32 v23, v23
    v_mfma_f32_32x32x16_bf16 v[48:63], v[112:115], v[100:103], v[48:63]
    ds_read_b128 v[108:111], v119 offset:9728
    v_exp_f32 v24, v24
    v_exp_f32 v25, v25
    v_exp_f32 v26, v26
    v_smfmac_f32_32x32x32_bf16 v[64:79], v[132:135], v[16:23], v118
    s_waitcnt lgkmcnt(1)
    ds_read_b128 v[112:115], v119 offset:10752
    v_exp_f32 v27, v27
    v_exp_f32 v28, v28
    v_exp_f32 v29, v29
    v_exp_f32 v30, v30
    v_exp_f32 v31, v31
    v_exp_f32 v32, v32
    v_exp_f32 v33, v33
    v_smfmac_f32_32x32x32_bf16 v[64:79], v[136:139], v[24:31], v118
    s_add_u32 s59, s4, 2
    s_and_b32 s59, s59, 3
    s_mul_i32 s59, s59, 5120
    s_add_u32 s26, s59, s24
    buffer_load_dwordx4 v[172:175], v148, s[8:11], s26 offen offset:0 sc1
    buffer_load_dwordx4 v[176:179], v148, s[8:11], s26 offen offset:1024 sc1
    v_exp_f32 v34, v34
    v_exp_f32 v35, v35
    v_exp_f32 v36, v36
    v_mfma_f32_32x32x4_2b_bf16 v[0:31], v[116:117], v[104:105], 0
    buffer_load_dwordx4 v[180:183], v148, s[8:11], s26 offen offset:2048 sc1
    v_exp_f32 v37, v37
    v_exp_f32 v38, v38
    v_exp_f32 v39, v39
    v_exp_f32 v40, v40
    v_exp_f32 v41, v41
    v_exp_f32 v42, v42
    v_exp_f32 v43, v43
    v_exp_f32 v44, v44
    v_smfmac_f32_32x32x32_bf16 v[80:95], v[124:127], v[32:39], v118
    ds_read_b64_tr_b16 v[124:125], v140 offset:9728
    v_exp_f32 v45, v45
    v_exp_f32 v46, v46
    v_exp_f32 v47, v47
    v_exp_f32 v48, v48
    v_exp_f32 v49, v49
    v_smfmac_f32_32x32x32_bf16 v[80:95], v[128:131], v[40:47], v118
    s_waitcnt lgkmcnt(1)
    ds_read_b64_tr_b16 v[126:127], v140 offset:9856
    v_exp_f32 v50, v50
    v_exp_f32 v51, v51
    v_exp_f32 v52, v52
    v_mfma_f32_32x32x16_bf16 v[0:15], v[108:111], v[96:99], v[0:15]
    ds_read_b64_tr_b16 v[128:129], v141 offset:9728
    v_exp_f32 v53, v53
    v_exp_f32 v54, v54
    v_exp_f32 v55, v55
    v_mfma_f32_32x32x16_bf16 v[16:31], v[112:115], v[96:99], v[16:31]
    ds_read_b64_tr_b16 v[130:131], v141 offset:9856
    v_exp_f32 v56, v56
    v_exp_f32 v57, v57
    v_exp_f32 v58, v58
    v_smfmac_f32_32x32x32_bf16 v[80:95], v[132:135], v[48:55], v118
    ds_read_b64_tr_b16 v[132:133], v142 offset:9728
    v_exp_f32 v59, v59
    v_exp_f32 v60, v60
    v_exp_f32 v61, v61
    v_exp_f32 v62, v62
    v_exp_f32 v63, v63
    v_exp_f32 v0, v0
    v_exp_f32 v1, v1
    v_smfmac_f32_32x32x32_bf16 v[80:95], v[136:139], v[56:63], v118
    s_waitcnt lgkmcnt(1)
    ds_read_b64_tr_b16 v[134:135], v142 offset:9856
    v_exp_f32 v2, v2
    v_exp_f32 v3, v3
    v_exp_f32 v4, v4
    v_mfma_f32_32x32x4_2b_bf16 v[32:63], v[116:117], v[106:107], 0
    buffer_load_dwordx4 v[184:187], v148, s[8:11], s26 offen offset:3072 sc1
    v_exp_f32 v5, v5
    v_exp_f32 v6, v6
    v_exp_f32 v7, v7
    v_exp_f32 v8, v8
    v_exp_f32 v9, v9
    v_exp_f32 v10, v10
    v_exp_f32 v11, v11
    v_exp_f32 v12, v12
    v_smfmac_f32_32x32x32_bf16 v[64:79], v[124:127], v[0:7], v118
    ds_read_b32 v116, v120 offset:14592
    v_exp_f32 v13, v13
    v_exp_f32 v14, v14
    v_exp_f32 v15, v15
    v_exp_f32 v16, v16
    v_exp_f32 v17, v17
    v_smfmac_f32_32x32x32_bf16 v[64:79], v[128:131], v[8:15], v118
    s_waitcnt lgkmcnt(1)
    ds_read_b64_tr_b16 v[136:137], v143 offset:9728
    v_exp_f32 v18, v18
    v_exp_f32 v19, v19
    v_exp_f32 v20, v20
    v_mfma_f32_32x32x16_bf16 v[32:47], v[108:111], v[100:103], v[32:47]
    ds_read_b64_tr_b16 v[138:139], v143 offset:9856
    v_exp_f32 v21, v21
    v_exp_f32 v22, v22
    v_exp_f32 v23, v23
    v_mfma_f32_32x32x16_bf16 v[48:63], v[112:115], v[100:103], v[48:63]
    ds_read_b128 v[108:111], v119 offset:14592
    v_exp_f32 v24, v24
    v_exp_f32 v25, v25
    v_exp_f32 v26, v26
    v_smfmac_f32_32x32x32_bf16 v[64:79], v[132:135], v[16:23], v118
    s_waitcnt lgkmcnt(1)
    ds_read_b128 v[112:115], v119 offset:15616
    v_exp_f32 v27, v27
    v_exp_f32 v28, v28
    v_exp_f32 v29, v29
    v_exp_f32 v30, v30
    v_exp_f32 v31, v31
    v_exp_f32 v32, v32
    v_exp_f32 v33, v33
    v_smfmac_f32_32x32x32_bf16 v[64:79], v[136:139], v[24:31], v118
    buffer_load_dwordx4 v[188:191], v151, s[8:11], s26 offen offset:0 sc1
    s_add_u32 s59, s4, 3
    s_and_b32 s59, s59, 3
    s_mul_i32 s59, s59, 5120
    s_add_u32 s26, s59, s24
    buffer_load_dwordx4 v[192:195], v148, s[8:11], s26 offen offset:0 sc1
    v_exp_f32 v34, v34
    v_exp_f32 v35, v35
    v_exp_f32 v36, v36
    v_mfma_f32_32x32x4_2b_bf16 v[0:31], v[116:117], v[104:105], 0
    buffer_load_dwordx4 v[196:199], v148, s[8:11], s26 offen offset:1024 sc1
    v_exp_f32 v37, v37
    v_exp_f32 v38, v38
    v_exp_f32 v39, v39
    v_exp_f32 v40, v40
    v_exp_f32 v41, v41
    v_exp_f32 v42, v42
    v_exp_f32 v43, v43
    v_exp_f32 v44, v44
    v_smfmac_f32_32x32x32_bf16 v[80:95], v[124:127], v[32:39], v118
    ds_read_b64_tr_b16 v[124:125], v140 offset:14592
    v_exp_f32 v45, v45
    v_exp_f32 v46, v46
    v_exp_f32 v47, v47
    v_exp_f32 v48, v48
    v_exp_f32 v49, v49
    v_smfmac_f32_32x32x32_bf16 v[80:95], v[128:131], v[40:47], v118
    s_waitcnt lgkmcnt(1)
    ds_read_b64_tr_b16 v[126:127], v140 offset:14720
    v_exp_f32 v50, v50
    v_exp_f32 v51, v51
    v_exp_f32 v52, v52
    v_mfma_f32_32x32x16_bf16 v[0:15], v[108:111], v[96:99], v[0:15]
    ds_read_b64_tr_b16 v[128:129], v141 offset:14592
    v_exp_f32 v53, v53
    v_exp_f32 v54, v54
    v_exp_f32 v55, v55
    v_mfma_f32_32x32x16_bf16 v[16:31], v[112:115], v[96:99], v[16:31]
    ds_read_b64_tr_b16 v[130:131], v141 offset:14720
    v_exp_f32 v56, v56
    v_exp_f32 v57, v57
    v_exp_f32 v58, v58
    v_smfmac_f32_32x32x32_bf16 v[80:95], v[132:135], v[48:55], v118
    ds_read_b64_tr_b16 v[132:133], v142 offset:14592
    v_exp_f32 v59, v59
    v_exp_f32 v60, v60
    v_exp_f32 v61, v61
    v_exp_f32 v62, v62
    v_exp_f32 v63, v63
    v_exp_f32 v0, v0
    v_exp_f32 v1, v1
    v_smfmac_f32_32x32x32_bf16 v[80:95], v[136:139], v[56:63], v118
    s_waitcnt lgkmcnt(1)
    ds_read_b64_tr_b16 v[134:135], v142 offset:14720
    v_exp_f32 v2, v2
    v_exp_f32 v3, v3
    v_exp_f32 v4, v4
    v_mfma_f32_32x32x4_2b_bf16 v[32:63], v[116:117], v[106:107], 0
    buffer_load_dwordx4 v[200:203], v148, s[8:11], s26 offen offset:2048 sc1
    v_exp_f32 v5, v5
    v_exp_f32 v6, v6
    v_exp_f32 v7, v7
    v_exp_f32 v8, v8
    v_exp_f32 v9, v9
    v_exp_f32 v10, v10
    v_exp_f32 v11, v11
    v_exp_f32 v12, v12
    v_smfmac_f32_32x32x32_bf16 v[64:79], v[124:127], v[0:7], v118
    ds_read_b32 v116, v120 offset:19456
    v_exp_f32 v13, v13
    v_exp_f32 v14, v14
    v_exp_f32 v15, v15
    v_exp_f32 v16, v16
    v_exp_f32 v17, v17
    v_smfmac_f32_32x32x32_bf16 v[64:79], v[128:131], v[8:15], v118
    s_waitcnt lgkmcnt(1)
    ds_read_b64_tr_b16 v[136:137], v143 offset:14592
    v_exp_f32 v18, v18
    v_exp_f32 v19, v19
    v_exp_f32 v20, v20
    v_mfma_f32_32x32x16_bf16 v[32:47], v[108:111], v[100:103], v[32:47]
    ds_read_b64_tr_b16 v[138:139], v143 offset:14720
    v_exp_f32 v21, v21
    v_exp_f32 v22, v22
    v_exp_f32 v23, v23
    v_mfma_f32_32x32x16_bf16 v[48:63], v[112:115], v[100:103], v[48:63]
    ds_read_b128 v[108:111], v119 offset:19456
    v_exp_f32 v24, v24
    v_exp_f32 v25, v25
    v_exp_f32 v26, v26
    v_smfmac_f32_32x32x32_bf16 v[64:79], v[132:135], v[16:23], v118
    s_waitcnt lgkmcnt(1)
    ds_read_b128 v[112:115], v119 offset:20480
    v_exp_f32 v27, v27
    v_exp_f32 v28, v28
    v_exp_f32 v29, v29
    v_exp_f32 v30, v30
    v_exp_f32 v31, v31
    v_exp_f32 v32, v32
    v_exp_f32 v33, v33
    v_smfmac_f32_32x32x32_bf16 v[64:79], v[136:139], v[24:31], v118
    buffer_load_dwordx4 v[204:207], v148, s[8:11], s26 offen offset:3072 sc1
    buffer_load_dwordx4 v[208:211], v151, s[8:11], s26 offen offset:0 sc1
    v_exp_f32 v34, v34
    v_exp_f32 v35, v35
    v_exp_f32 v36, v36
    v_mfma_f32_32x32x4_2b_bf16 v[0:31], v[116:117], v[104:105], 0
    s_add_u32 s59, s4, 4
    s_and_b32 s59, s59, 3
    s_mul_i32 s59, s59, 5120
    s_add_u32 s26, s59, s24
    buffer_load_dwordx4 v[212:215], v148, s[8:11], s26 offen offset:0 sc1
    v_exp_f32 v37, v37
    v_exp_f32 v38, v38
    v_exp_f32 v39, v39
    v_exp_f32 v40, v40
    v_exp_f32 v41, v41
    v_exp_f32 v42, v42
    v_exp_f32 v43, v43
    v_exp_f32 v44, v44
    v_smfmac_f32_32x32x32_bf16 v[80:95], v[124:127], v[32:39], v118
    ds_read_b64_tr_b16 v[124:125], v140 offset:19456
    v_exp_f32 v45, v45
    v_exp_f32 v46, v46
    v_exp_f32 v47, v47
    v_exp_f32 v48, v48
    v_exp_f32 v49, v49
    v_smfmac_f32_32x32x32_bf16 v[80:95], v[128:131], v[40:47], v118
    s_waitcnt lgkmcnt(1)
    ds_read_b64_tr_b16 v[126:127], v140 offset:19584
    v_exp_f32 v50, v50
    v_exp_f32 v51, v51
    v_exp_f32 v52, v52
    v_mfma_f32_32x32x16_bf16 v[0:15], v[108:111], v[96:99], v[0:15]
    ds_read_b64_tr_b16 v[128:129], v141 offset:19456
    v_exp_f32 v53, v53
    v_exp_f32 v54, v54
    v_exp_f32 v55, v55
    v_mfma_f32_32x32x16_bf16 v[16:31], v[112:115], v[96:99], v[16:31]
    ds_read_b64_tr_b16 v[130:131], v141 offset:19584
    v_exp_f32 v56, v56
    v_exp_f32 v57, v57
    v_exp_f32 v58, v58
    v_smfmac_f32_32x32x32_bf16 v[80:95], v[132:135], v[48:55], v118
    ds_read_b64_tr_b16 v[132:133], v142 offset:19456
    v_exp_f32 v59, v59
    v_exp_f32 v60, v60
    v_exp_f32 v61, v61
    v_exp_f32 v62, v62
    v_exp_f32 v63, v63
    v_exp_f32 v0, v0
    v_exp_f32 v1, v1
    v_smfmac_f32_32x32x32_bf16 v[80:95], v[136:139], v[56:63], v118
    s_waitcnt lgkmcnt(1)
    ds_read_b64_tr_b16 v[134:135], v142 offset:19584
    v_exp_f32 v2, v2
    v_exp_f32 v3, v3
    v_exp_f32 v4, v4
    v_mfma_f32_32x32x4_2b_bf16 v[32:63], v[116:117], v[106:107], 0
    buffer_load_dwordx4 v[216:219], v148, s[8:11], s26 offen offset:1024 sc1
    v_exp_f32 v5, v5
    v_exp_f32 v6, v6
    v_exp_f32 v7, v7
    v_exp_f32 v8, v8
    v_exp_f32 v9, v9
    v_exp_f32 v10, v10
    v_exp_f32 v11, v11
    v_exp_f32 v12, v12
    v_smfmac_f32_32x32x32_bf16 v[64:79], v[124:127], v[0:7], v118
    ds_read_b32 v116, v120 offset:24320
    v_exp_f32 v13, v13
    v_exp_f32 v14, v14
    v_exp_f32 v15, v15
    v_exp_f32 v16, v16
    v_exp_f32 v17, v17
    v_smfmac_f32_32x32x32_bf16 v[64:79], v[128:131], v[8:15], v118
    s_waitcnt lgkmcnt(1)
    ds_read_b64_tr_b16 v[136:137], v143 offset:19456
    v_exp_f32 v18, v18
    v_exp_f32 v19, v19
    v_exp_f32 v20, v20
    v_mfma_f32_32x32x16_bf16 v[32:47], v[108:111], v[100:103], v[32:47]
    ds_read_b64_tr_b16 v[138:139], v143 offset:19584
    v_exp_f32 v21, v21
    v_exp_f32 v22, v22
    v_exp_f32 v23, v23
    v_mfma_f32_32x32x16_bf16 v[48:63], v[112:115], v[100:103], v[48:63]
    ds_read_b128 v[108:111], v119 offset:24320
    v_exp_f32 v24, v24
    v_exp_f32 v25, v25
    v_exp_f32 v26, v26
    v_smfmac_f32_32x32x32_bf16 v[64:79], v[132:135], v[16:23], v118
    s_waitcnt lgkmcnt(1)
    ds_read_b128 v[112:115], v119 offset:25344
    v_exp_f32 v27, v27
    v_exp_f32 v28, v28
    v_exp_f32 v29, v29
    v_exp_f32 v30, v30
    v_exp_f32 v31, v31
    v_exp_f32 v32, v32
    v_exp_f32 v33, v33
    v_smfmac_f32_32x32x32_bf16 v[64:79], v[136:139], v[24:31], v118
    buffer_load_dwordx4 v[220:223], v148, s[8:11], s26 offen offset:2048 sc1
    buffer_load_dwordx4 v[224:227], v148, s[8:11], s26 offen offset:3072 sc1
    v_exp_f32 v34, v34
    v_exp_f32 v35, v35
    v_exp_f32 v36, v36
    v_mfma_f32_32x32x4_2b_bf16 v[0:31], v[116:117], v[104:105], 0
    buffer_load_dwordx4 v[228:231], v151, s[8:11], s26 offen offset:0 sc1
    v_exp_f32 v37, v37
    v_exp_f32 v38, v38
    v_exp_f32 v39, v39
    v_exp_f32 v40, v40
    v_exp_f32 v41, v41
    v_exp_f32 v42, v42
    v_exp_f32 v43, v43
    v_exp_f32 v44, v44
    v_smfmac_f32_32x32x32_bf16 v[80:95], v[124:127], v[32:39], v118
    ds_read_b64_tr_b16 v[124:125], v140 offset:24320
    v_exp_f32 v45, v45
    v_exp_f32 v46, v46
    v_exp_f32 v47, v47
    v_exp_f32 v48, v48
    v_exp_f32 v49, v49
    v_smfmac_f32_32x32x32_bf16 v[80:95], v[128:131], v[40:47], v118
    s_waitcnt lgkmcnt(1)
    ds_read_b64_tr_b16 v[126:127], v140 offset:24448
    v_exp_f32 v50, v50
    v_exp_f32 v51, v51
    v_exp_f32 v52, v52
    v_mfma_f32_32x32x16_bf16 v[0:15], v[108:111], v[96:99], v[0:15]
    ds_read_b64_tr_b16 v[128:129], v141 offset:24320
    v_exp_f32 v53, v53
    v_exp_f32 v54, v54
    v_exp_f32 v55, v55
    v_mfma_f32_32x32x16_bf16 v[16:31], v[112:115], v[96:99], v[16:31]
    ds_read_b64_tr_b16 v[130:131], v141 offset:24448
    v_exp_f32 v56, v56
    v_exp_f32 v57, v57
    v_exp_f32 v58, v58
    v_smfmac_f32_32x32x32_bf16 v[80:95], v[132:135], v[48:55], v118
    ds_read_b64_tr_b16 v[132:133], v142 offset:24320
    v_exp_f32 v59, v59
    v_exp_f32 v60, v60
    v_exp_f32 v61, v61
    v_exp_f32 v62, v62
    v_exp_f32 v63, v63
    v_exp_f32 v0, v0
    v_exp_f32 v1, v1
    v_smfmac_f32_32x32x32_bf16 v[80:95], v[136:139], v[56:63], v118
    s_waitcnt lgkmcnt(1)
    ds_read_b64_tr_b16 v[134:135], v142 offset:24448
    v_exp_f32 v2, v2
    v_exp_f32 v3, v3
    v_exp_f32 v4, v4
    v_mfma_f32_32x32x4_2b_bf16 v[32:63], v[116:117], v[106:107], 0
    s_add_u32 s26, s24, 20480
    buffer_load_dwordx2 v[232:233], v149, s[8:11], s26 offen offset:0 sc1
    v_exp_f32 v5, v5
    v_exp_f32 v6, v6
    v_exp_f32 v7, v7
    v_exp_f32 v8, v8
    v_exp_f32 v9, v9
    v_exp_f32 v10, v10
    v_exp_f32 v11, v11
    v_exp_f32 v12, v12
    v_smfmac_f32_32x32x32_bf16 v[64:79], v[124:127], v[0:7], v118
    ds_read_b32 v116, v120 offset:29184
    v_exp_f32 v13, v13
    v_exp_f32 v14, v14
    v_exp_f32 v15, v15
    v_exp_f32 v16, v16
    v_exp_f32 v17, v17
    v_smfmac_f32_32x32x32_bf16 v[64:79], v[128:131], v[8:15], v118
    s_waitcnt lgkmcnt(1)
    ds_read_b64_tr_b16 v[136:137], v143 offset:24320
    v_exp_f32 v18, v18
    v_exp_f32 v19, v19
    v_exp_f32 v20, v20
    v_mfma_f32_32x32x16_bf16 v[32:47], v[108:111], v[100:103], v[32:47]
    ds_read_b64_tr_b16 v[138:139], v143 offset:24448
    v_exp_f32 v21, v21
    v_exp_f32 v22, v22
    v_exp_f32 v23, v23
    v_mfma_f32_32x32x16_bf16 v[48:63], v[112:115], v[100:103], v[48:63]
    ds_read_b128 v[108:111], v119 offset:29184
    v_exp_f32 v24, v24
    v_exp_f32 v25, v25
    v_exp_f32 v26, v26
    v_smfmac_f32_32x32x32_bf16 v[64:79], v[132:135], v[16:23], v118
    s_waitcnt lgkmcnt(1)
    ds_read_b128 v[112:115], v119 offset:30208
    v_exp_f32 v27, v27
    v_exp_f32 v28, v28
    v_exp_f32 v29, v29
    v_exp_f32 v30, v30
    v_exp_f32 v31, v31
    v_exp_f32 v32, v32
    v_exp_f32 v33, v33
    v_smfmac_f32_32x32x32_bf16 v[64:79], v[136:139], v[24:31], v118
    buffer_load_dwordx2 v[234:235], v149, s[8:11], s26 offen offset:512 sc1
    buffer_load_dwordx2 v[236:237], v149, s[8:11], s26 offen offset:1024 sc1
    v_exp_f32 v34, v34
    v_exp_f32 v35, v35
    v_exp_f32 v36, v36
    v_mfma_f32_32x32x4_2b_bf16 v[0:31], v[116:117], v[104:105], 0
    buffer_load_dwordx2 v[238:239], v149, s[8:11], s26 offen offset:1536 sc1
    v_exp_f32 v37, v37
    v_exp_f32 v38, v38
    v_exp_f32 v39, v39
    v_exp_f32 v40, v40
    v_exp_f32 v41, v41
    v_exp_f32 v42, v42
    v_exp_f32 v43, v43
    v_exp_f32 v44, v44
    v_smfmac_f32_32x32x32_bf16 v[80:95], v[124:127], v[32:39], v118
    ds_read_b64_tr_b16 v[124:125], v140 offset:29184
    v_exp_f32 v45, v45
    v_exp_f32 v46, v46
    v_exp_f32 v47, v47
    v_exp_f32 v48, v48
    v_exp_f32 v49, v49
    v_smfmac_f32_32x32x32_bf16 v[80:95], v[128:131], v[40:47], v118
    s_waitcnt lgkmcnt(1)
    ds_read_b64_tr_b16 v[126:127], v140 offset:29312
    v_exp_f32 v50, v50
    v_exp_f32 v51, v51
    v_exp_f32 v52, v52
    v_mfma_f32_32x32x16_bf16 v[0:15], v[108:111], v[96:99], v[0:15]
    ds_read_b64_tr_b16 v[128:129], v141 offset:29184
    v_exp_f32 v53, v53
    v_exp_f32 v54, v54
    v_exp_f32 v55, v55
    v_mfma_f32_32x32x16_bf16 v[16:31], v[112:115], v[96:99], v[16:31]
    ds_read_b64_tr_b16 v[130:131], v141 offset:29312
    v_exp_f32 v56, v56
    v_exp_f32 v57, v57
    v_exp_f32 v58, v58
    v_smfmac_f32_32x32x32_bf16 v[80:95], v[132:135], v[48:55], v118
    ds_read_b64_tr_b16 v[132:133], v142 offset:29184
    v_exp_f32 v59, v59
    v_exp_f32 v60, v60
    v_exp_f32 v61, v61
    v_exp_f32 v62, v62
    v_exp_f32 v63, v63
    v_exp_f32 v0, v0
    v_exp_f32 v1, v1
    v_smfmac_f32_32x32x32_bf16 v[80:95], v[136:139], v[56:63], v118
    s_waitcnt lgkmcnt(1)
    ds_read_b64_tr_b16 v[134:135], v142 offset:29312
    v_exp_f32 v2, v2
    v_exp_f32 v3, v3
    v_exp_f32 v4, v4
    v_mfma_f32_32x32x4_2b_bf16 v[32:63], v[116:117], v[106:107], 0
    buffer_load_dwordx2 v[240:241], v149, s[8:11], s26 offen offset:2048 sc1
    v_exp_f32 v5, v5
    v_exp_f32 v6, v6
    v_exp_f32 v7, v7
    v_exp_f32 v8, v8
    v_exp_f32 v9, v9
    v_exp_f32 v10, v10
    v_exp_f32 v11, v11
    v_exp_f32 v12, v12
    v_smfmac_f32_32x32x32_bf16 v[64:79], v[124:127], v[0:7], v118
    ds_read_b32 v116, v120 offset:34048
    v_exp_f32 v13, v13
    v_exp_f32 v14, v14
    v_exp_f32 v15, v15
    v_exp_f32 v16, v16
    v_exp_f32 v17, v17
    v_smfmac_f32_32x32x32_bf16 v[64:79], v[128:131], v[8:15], v118
    s_waitcnt lgkmcnt(1)
    ds_read_b64_tr_b16 v[136:137], v143 offset:29184
    v_exp_f32 v18, v18
    v_exp_f32 v19, v19
    v_exp_f32 v20, v20
    v_mfma_f32_32x32x16_bf16 v[32:47], v[108:111], v[100:103], v[32:47]
    ds_read_b64_tr_b16 v[138:139], v143 offset:29312
    v_exp_f32 v21, v21
    v_exp_f32 v22, v22
    v_exp_f32 v23, v23
    v_mfma_f32_32x32x16_bf16 v[48:63], v[112:115], v[100:103], v[48:63]
    ds_read_b128 v[108:111], v119 offset:34048
    v_exp_f32 v24, v24
    v_exp_f32 v25, v25
    v_exp_f32 v26, v26
    v_smfmac_f32_32x32x32_bf16 v[64:79], v[132:135], v[16:23], v118
    s_waitcnt lgkmcnt(1)
    ds_read_b128 v[112:115], v119 offset:35072
    v_exp_f32 v27, v27
    v_exp_f32 v28, v28
    v_exp_f32 v29, v29
    v_exp_f32 v30, v30
    v_exp_f32 v31, v31
    v_exp_f32 v32, v32
    v_exp_f32 v33, v33
    v_smfmac_f32_32x32x32_bf16 v[64:79], v[136:139], v[24:31], v118
    buffer_load_dword v242, v150, s[8:11], s25 offen sc1
    s_add_u32 s26, s25, 8192
    buffer_load_dword v243, v150, s[8:11], s26 offen sc1
    v_exp_f32 v34, v34
    v_exp_f32 v35, v35
    v_exp_f32 v36, v36
    v_mfma_f32_32x32x4_2b_bf16 v[0:31], v[116:117], v[104:105], 0
    v_exp_f32 v37, v37
    v_exp_f32 v38, v38
    v_exp_f32 v39, v39
    v_exp_f32 v40, v40
    v_exp_f32 v41, v41
    v_exp_f32 v42, v42
    v_exp_f32 v43, v43
    v_exp_f32 v44, v44
    v_smfmac_f32_32x32x32_bf16 v[80:95], v[124:127], v[32:39], v118
    ds_read_b64_tr_b16 v[124:125], v140 offset:34048
    v_exp_f32 v45, v45
    v_exp_f32 v46, v46
    v_exp_f32 v47, v47
    v_exp_f32 v48, v48
    v_exp_f32 v49, v49
    v_smfmac_f32_32x32x32_bf16 v[80:95], v[128:131], v[40:47], v118
    s_waitcnt lgkmcnt(1)
    ds_read_b64_tr_b16 v[126:127], v140 offset:34176
    v_exp_f32 v50, v50
    v_exp_f32 v51, v51
    v_exp_f32 v52, v52
    v_mfma_f32_32x32x16_bf16 v[0:15], v[108:111], v[96:99], v[0:15]
    ds_read_b64_tr_b16 v[128:129], v141 offset:34048
    v_exp_f32 v53, v53
    v_exp_f32 v54, v54
    v_exp_f32 v55, v55
    v_mfma_f32_32x32x16_bf16 v[16:31], v[112:115], v[96:99], v[16:31]
    ds_read_b64_tr_b16 v[130:131], v141 offset:34176
    v_exp_f32 v56, v56
    v_exp_f32 v57, v57
    v_exp_f32 v58, v58
    v_smfmac_f32_32x32x32_bf16 v[80:95], v[132:135], v[48:55], v118
    ds_read_b64_tr_b16 v[132:133], v142 offset:34048
    v_exp_f32 v59, v59
    v_exp_f32 v60, v60
    v_exp_f32 v61, v61
    v_exp_f32 v62, v62
    v_exp_f32 v63, v63
    v_exp_f32 v0, v0
    v_exp_f32 v1, v1
    v_smfmac_f32_32x32x32_bf16 v[80:95], v[136:139], v[56:63], v118
    s_waitcnt lgkmcnt(1)
    ds_read_b64_tr_b16 v[134:135], v142 offset:34176
    v_exp_f32 v2, v2
    v_exp_f32 v3, v3
    v_exp_f32 v4, v4
    v_mfma_f32_32x32x4_2b_bf16 v[32:63], v[116:117], v[106:107], 0
    s_cmp_lt_u32 s3, 4
    s_cbranch_scc0 .Lpr13
    s_setprio 0
.Lpr13:
    v_exp_f32 v5, v5
    v_exp_f32 v6, v6
    v_exp_f32 v7, v7
    v_exp_f32 v8, v8
    v_exp_f32 v9, v9
    v_exp_f32 v10, v10
    v_exp_f32 v11, v11
    v_exp_f32 v12, v12
    v_smfmac_f32_32x32x32_bf16 v[64:79], v[124:127], v[0:7], v118
    ds_read_b32 v116, v120 offset:38912
    v_exp_f32 v13, v13
    v_exp_f32 v14, v14
    v_exp_f32 v15, v15
    v_exp_f32 v16, v16
    v_exp_f32 v17, v17
    v_smfmac_f32_32x32x32_bf16 v[64:79], v[128:131], v[8:15], v118
    s_waitcnt lgkmcnt(1)
    ds_read_b64_tr_b16 v[136:137], v143 offset:34048
    v_exp_f32 v18, v18
    v_exp_f32 v19, v19
    v_exp_f32 v20, v20
    v_mfma_f32_32x32x16_bf16 v[32:47], v[108:111], v[100:103], v[32:47]
    ds_read_b64_tr_b16 v[138:139], v143 offset:34176
    v_exp_f32 v21, v21
    v_exp_f32 v22, v22
    v_exp_f32 v23, v23
    v_mfma_f32_32x32x16_bf16 v[48:63], v[112:115], v[100:103], v[48:63]
    ds_read_b128 v[108:111], v119 offset:38912
    v_exp_f32 v24, v24
    v_exp_f32 v25, v25
    v_exp_f32 v26, v26
    v_smfmac_f32_32x32x32_bf16 v[64:79], v[132:135], v[16:23], v118
    s_waitcnt lgkmcnt(1)
    ds_read_b128 v[112:115], v119 offset:39936
    v_exp_f32 v27, v27
    v_exp_f32 v28, v28
    v_exp_f32 v29, v29
    v_exp_f32 v30, v30
    v_exp_f32 v31, v31
    v_exp_f32 v32, v32
    v_exp_f32 v33, v33
    v_smfmac_f32_32x32x32_bf16 v[64:79], v[136:139], v[24:31], v118
    v_exp_f32 v34, v34
    v_exp_f32 v35, v35
    v_exp_f32 v36, v36
    v_mfma_f32_32x32x4_2b_bf16 v[0:31], v[116:117], v[104:105], 0
    v_exp_f32 v37, v37
    v_exp_f32 v38, v38
    v_exp_f32 v39, v39
    v_exp_f32 v40, v40
    v_exp_f32 v41, v41
    v_exp_f32 v42, v42
    v_exp_f32 v43, v43
    v_exp_f32 v44, v44
    v_smfmac_f32_32x32x32_bf16 v[80:95], v[124:127], v[32:39], v118
    ds_read_b64_tr_b16 v[124:125], v140 offset:38912
    v_exp_f32 v45, v45
    v_exp_f32 v46, v46
    v_exp_f32 v47, v47
    v_exp_f32 v48, v48
    v_exp_f32 v49, v49
    v_smfmac_f32_32x32x32_bf16 v[80:95], v[128:131], v[40:47], v118
    s_waitcnt lgkmcnt(1)
    ds_read_b64_tr_b16 v[126:127], v140 offset:39040
    v_exp_f32 v50, v50
    v_exp_f32 v51, v51
    v_exp_f32 v52, v52
    v_mfma_f32_32x32x16_bf16 v[0:15], v[108:111], v[96:99], v[0:15]
    ds_read_b64_tr_b16 v[128:129], v141 offset:38912
    v_exp_f32 v53, v53
    v_exp_f32 v54, v54
    v_exp_f32 v55, v55
    v_mfma_f32_32x32x16_bf16 v[16:31], v[112:115], v[96:99], v[16:31]
    ds_read_b64_tr_b16 v[130:131], v141 offset:39040
    v_exp_f32 v56, v56
    v_exp_f32 v57, v57
    v_exp_f32 v58, v58
    v_smfmac_f32_32x32x32_bf16 v[80:95], v[132:135], v[48:55], v118
    ds_read_b64_tr_b16 v[132:133], v142 offset:38912
    v_exp_f32 v59, v59
    v_exp_f32 v60, v60
    v_exp_f32 v61, v61
    v_exp_f32 v62, v62
    v_exp_f32 v63, v63
    v_add_u32 v119, 38912, v119
    v_add_u32 v120, 38912, v120
    v_add_u32 v140, 38912, v140
    v_add_u32 v141, 38912, v141
    v_add_u32 v142, 38912, v142
    v_add_u32 v143, 38912, v143
    s_mov_b32 s54, 2
.p2align 6
.Lattn_loop:
    v_exp_f32 v0, v0
    v_exp_f32 v1, v1
    v_smfmac_f32_32x32x32_bf16 v[80:95], v[136:139], v[56:63], v118
    s_waitcnt lgkmcnt(1)
    ds_read_b64_tr_b16 v[134:135], v142 offset:128
    v_exp_f32 v2, v2
    v_exp_f32 v3, v3
    v_exp_f32 v4, v4
    v_mfma_f32_32x32x4_2b_bf16 v[32:63], v[116:117], v[106:107], 0
    s_cmp_lt_u32 s3, 4
    s_cbranch_scc0 .Lpr14
    s_setprio 2
.Lpr14:
    v_exp_f32 v5, v5
    v_exp_f32 v6, v6
    v_exp_f32 v7, v7
    v_exp_f32 v8, v8
    v_exp_f32 v9, v9
    v_exp_f32 v10, v10
    v_exp_f32 v11, v11
    v_exp_f32 v12, v12
    v_smfmac_f32_32x32x32_bf16 v[64:79], v[124:127], v[0:7], v118
    ds_read_b32 v116, v120 offset:4864
    v_exp_f32 v13, v13
    v_exp_f32 v14, v14
    v_exp_f32 v15, v15
    v_exp_f32 v16, v16
    v_exp_f32 v17, v17
    v_smfmac_f32_32x32x32_bf16 v[64:79], v[128:131], v[8:15], v118
    s_waitcnt lgkmcnt(1)
    ds_read_b64_tr_b16 v[136:137], v143 offset:0
    v_exp_f32 v18, v18
    v_exp_f32 v19, v19
    v_exp_f32 v20, v20
    v_mfma_f32_32x32x16_bf16 v[32:47], v[108:111], v[100:103], v[32:47]
    ds_read_b64_tr_b16 v[138:139], v143 offset:128
    v_exp_f32 v21, v21
    v_exp_f32 v22, v22
    v_exp_f32 v23, v23
    v_mfma_f32_32x32x16_bf16 v[48:63], v[112:115], v[100:103], v[48:63]
    ds_read_b128 v[108:111], v119 offset:4864
    v_exp_f32 v24, v24
    v_exp_f32 v25, v25
    v_exp_f32 v26, v26
    v_smfmac_f32_32x32x32_bf16 v[64:79], v[132:135], v[16:23], v118
    s_waitcnt lgkmcnt(1)
    ds_read_b128 v[112:115], v119 offset:5888
    v_exp_f32 v27, v27
    v_exp_f32 v28, v28
    v_exp_f32 v29, v29
    v_exp_f32 v30, v30
    v_exp_f32 v31, v31
    v_exp_f32 v32, v32
    v_exp_f32 v33, v33
    v_smfmac_f32_32x32x32_bf16 v[64:79], v[136:139], v[24:31], v118
    v_exp_f32 v34, v34
    v_exp_f32 v35, v35
    v_exp_f32 v36, v36
    v_mfma_f32_32x32x4_2b_bf16 v[0:31], v[116:117], v[104:105], 0
    v_exp_f32 v37, v37
    v_exp_f32 v38, v38
    v_exp_f32 v39, v39
    v_exp_f32 v40, v40
    v_exp_f32 v41, v41
    v_exp_f32 v42, v42
    v_exp_f32 v43, v43
    v_exp_f32 v44, v44
    v_smfmac_f32_32x32x32_bf16 v[80:95], v[124:127], v[32:39], v118
    ds_read_b64_tr_b16 v[124:125], v140 offset:4864
    v_exp_f32 v45, v45
    v_exp_f32 v46, v46
    v_exp_f32 v47, v47
    v_exp_f32 v48, v48
    v_exp_f32 v49, v49
    v_smfmac_f32_32x32x32_bf16 v[80:95], v[128:131], v[40:47], v118
    s_waitcnt lgkmcnt(1)
    ds_read_b64_tr_b16 v[126:127], v140 offset:4992
    v_exp_f32 v50, v50
    v_exp_f32 v51, v51
    v_exp_f32 v52, v52
    v_mfma_f32_32x32x16_bf16 v[0:15], v[108:111], v[96:99], v[0:15]
    ds_read_b64_tr_b16 v[128:129], v141 offset:4864
    v_exp_f32 v53, v53
    v_exp_f32 v54, v54
    v_exp_f32 v55, v55
    v_mfma_f32_32x32x16_bf16 v[16:31], v[112:115], v[96:99], v[16:31]
    ds_read_b64_tr_b16 v[130:131], v141 offset:4992
    v_exp_f32 v56, v56
    v_exp_f32 v57, v57
    v_exp_f32 v58, v58
    v_smfmac_f32_32x32x32_bf16 v[80:95], v[132:135], v[48:55], v118
    ds_read_b64_tr_b16 v[132:133], v142 offset:4864
    v_exp_f32 v59, v59
    v_exp_f32 v60, v60
    v_exp_f32 v61, v61
    v_exp_f32 v62, v62
    v_exp_f32 v63, v63
    v_exp_f32 v0, v0
    v_exp_f32 v1, v1
    v_smfmac_f32_32x32x32_bf16 v[80:95], v[136:139], v[56:63], v118
    s_waitcnt lgkmcnt(1)
    ds_read_b64_tr_b16 v[134:135], v142 offset:4992
    v_exp_f32 v2, v2
    v_exp_f32 v3, v3
    v_exp_f32 v4, v4
    v_mfma_f32_32x32x4_2b_bf16 v[32:63], v[116:117], v[106:107], 0
    v_exp_f32 v5, v5
    v_exp_f32 v6, v6
    v_exp_f32 v7, v7
    v_exp_f32 v8, v8
    v_exp_f32 v9, v9
    v_exp_f32 v10, v10
    v_exp_f32 v11, v11
    v_exp_f32 v12, v12
    v_smfmac_f32_32x32x32_bf16 v[64:79], v[124:127], v[0:7], v118
    ds_read_b32 v116, v120 offset:9728
    v_exp_f32 v13, v13
    v_exp_f32 v14, v14
    v_exp_f32 v15, v15
    v_exp_f32 v16, v16
    v_exp_f32 v17, v17
    v_smfmac_f32_32x32x32_bf16 v[64:79], v[128:131], v[8:15], v118
    s_waitcnt lgkmcnt(1)
    ds_read_b64_tr_b16 v[136:137], v143 offset:4864
    v_exp_f32 v18, v18
    v_exp_f32 v19, v19
    v_exp_f32 v20, v20
    v_mfma_f32_32x32x16_bf16 v[32:47], v[108:111], v[100:103], v[32:47]
    ds_read_b64_tr_b16 v[138:139], v143 offset:4992
    v_exp_f32 v21, v21
    v_exp_f32 v22, v22
    v_exp_f32 v23, v23
    v_mfma_f32_32x32x16_bf16 v[48:63], v[112:115], v[100:103], v[48:63]
    ds_read_b128 v[108:111], v119 offset:9728
    v_exp_f32 v24, v24
    v_exp_f32 v25, v25
    v_exp_f32 v26, v26
    v_smfmac_f32_32x32x32_bf16 v[64:79], v[132:135], v[16:23], v118
    s_waitcnt lgkmcnt(1)
    ds_read_b128 v[112:115], v119 offset:10752
    v_exp_f32 v27, v27
    v_exp_f32 v28, v28
    v_exp_f32 v29, v29
    v_exp_f32 v30, v30
    v_exp_f32 v31, v31
    v_exp_f32 v32, v32
    v_exp_f32 v33, v33
    v_smfmac_f32_32x32x32_bf16 v[64:79], v[136:139], v[24:31], v118
    v_exp_f32 v34, v34
    v_exp_f32 v35, v35
    v_exp_f32 v36, v36
    v_mfma_f32_32x32x4_2b_bf16 v[0:31], v[116:117], v[104:105], 0
    v_exp_f32 v37, v37
    v_exp_f32 v38, v38
    v_exp_f32 v39, v39
    v_exp_f32 v40, v40
    v_exp_f32 v41, v41
    v_exp_f32 v42, v42
    v_exp_f32 v43, v43
    v_exp_f32 v44, v44
    v_smfmac_f32_32x32x32_bf16 v[80:95], v[124:127], v[32:39], v118
    ds_read_b64_tr_b16 v[124:125], v140 offset:9728
    v_exp_f32 v45, v45
    v_exp_f32 v46, v46
    v_exp_f32 v47, v47
    v_exp_f32 v48, v48
    v_exp_f32 v49, v49
    v_smfmac_f32_32x32x32_bf16 v[80:95], v[128:131], v[40:47], v118
    s_waitcnt lgkmcnt(1)
    ds_read_b64_tr_b16 v[126:127], v140 offset:9856
    v_exp_f32 v50, v50
    v_exp_f32 v51, v51
    v_exp_f32 v52, v52
    v_mfma_f32_32x32x16_bf16 v[0:15], v[108:111], v[96:99], v[0:15]
    ds_read_b64_tr_b16 v[128:129], v141 offset:9728
    v_exp_f32 v53, v53
    v_exp_f32 v54, v54
    v_exp_f32 v55, v55
    v_mfma_f32_32x32x16_bf16 v[16:31], v[112:115], v[96:99], v[16:31]
    ds_read_b64_tr_b16 v[130:131], v141 offset:9856
    v_exp_f32 v56, v56
    v_exp_f32 v57, v57
    v_exp_f32 v58, v58
    v_smfmac_f32_32x32x32_bf16 v[80:95], v[132:135], v[48:55], v118
    ds_read_b64_tr_b16 v[132:133], v142 offset:9728
    v_exp_f32 v59, v59
    v_exp_f32 v60, v60
    v_exp_f32 v61, v61
    v_exp_f32 v62, v62
    v_exp_f32 v63, v63
    v_exp_f32 v0, v0
    v_exp_f32 v1, v1
    v_smfmac_f32_32x32x32_bf16 v[80:95], v[136:139], v[56:63], v118
    s_waitcnt lgkmcnt(1)
    ds_read_b64_tr_b16 v[134:135], v142 offset:9856
    v_exp_f32 v2, v2
    v_exp_f32 v3, v3
    v_exp_f32 v4, v4
    v_mfma_f32_32x32x4_2b_bf16 v[32:63], v[116:117], v[106:107], 0
    v_exp_f32 v5, v5
    v_exp_f32 v6, v6
    v_exp_f32 v7, v7
    v_exp_f32 v8, v8
    v_exp_f32 v9, v9
    v_exp_f32 v10, v10
    v_exp_f32 v11, v11
    v_exp_f32 v12, v12
    v_smfmac_f32_32x32x32_bf16 v[64:79], v[124:127], v[0:7], v118
    ds_read_b32 v116, v120 offset:14592
    v_exp_f32 v13, v13
    v_exp_f32 v14, v14
    v_exp_f32 v15, v15
    v_exp_f32 v16, v16
    v_exp_f32 v17, v17
    v_smfmac_f32_32x32x32_bf16 v[64:79], v[128:131], v[8:15], v118
    s_waitcnt lgkmcnt(1)
    ds_read_b64_tr_b16 v[136:137], v143 offset:9728
    v_exp_f32 v18, v18
    v_exp_f32 v19, v19
    v_exp_f32 v20, v20
    v_mfma_f32_32x32x16_bf16 v[32:47], v[108:111], v[100:103], v[32:47]
    ds_read_b64_tr_b16 v[138:139], v143 offset:9856
    v_exp_f32 v21, v21
    v_exp_f32 v22, v22
    v_exp_f32 v23, v23
    v_mfma_f32_32x32x16_bf16 v[48:63], v[112:115], v[100:103], v[48:63]
    ds_read_b128 v[108:111], v119 offset:14592
    v_exp_f32 v24, v24
    v_exp_f32 v25, v25
    v_exp_f32 v26, v26
    v_smfmac_f32_32x32x32_bf16 v[64:79], v[132:135], v[16:23], v118
    s_waitcnt lgkmcnt(1)
    ds_read_b128 v[112:115], v119 offset:15616
    v_exp_f32 v27, v27
    v_exp_f32 v28, v28
    v_exp_f32 v29, v29
    v_exp_f32 v30, v30
    v_exp_f32 v31, v31
    v_exp_f32 v32, v32
    v_exp_f32 v33, v33
    v_smfmac_f32_32x32x32_bf16 v[64:79], v[136:139], v[24:31], v118
    v_exp_f32 v34, v34
    v_exp_f32 v35, v35
    v_exp_f32 v36, v36
    v_mfma_f32_32x32x4_2b_bf16 v[0:31], v[116:117], v[104:105], 0
    v_exp_f32 v37, v37
    v_exp_f32 v38, v38
    v_exp_f32 v39, v39
    v_exp_f32 v40, v40
    v_exp_f32 v41, v41
    v_exp_f32 v42, v42
    v_exp_f32 v43, v43
    v_exp_f32 v44, v44
    v_smfmac_f32_32x32x32_bf16 v[80:95], v[124:127], v[32:39], v118
    ds_read_b64_tr_b16 v[124:125], v140 offset:14592
    v_exp_f32 v45, v45
    v_exp_f32 v46, v46
    v_exp_f32 v47, v47
    v_exp_f32 v48, v48
    v_exp_f32 v49, v49
    v_smfmac_f32_32x32x32_bf16 v[80:95], v[128:131], v[40:47], v118
    s_waitcnt lgkmcnt(1)
    ds_read_b64_tr_b16 v[126:127], v140 offset:14720
    v_exp_f32 v50, v50
    v_exp_f32 v51, v51
    v_exp_f32 v52, v52
    v_mfma_f32_32x32x16_bf16 v[0:15], v[108:111], v[96:99], v[0:15]
    ds_read_b64_tr_b16 v[128:129], v141 offset:14592
    v_exp_f32 v53, v53
    v_exp_f32 v54, v54
    v_exp_f32 v55, v55
    v_mfma_f32_32x32x16_bf16 v[16:31], v[112:115], v[96:99], v[16:31]
    ds_read_b64_tr_b16 v[130:131], v141 offset:14720
    v_exp_f32 v56, v56
    v_exp_f32 v57, v57
    v_exp_f32 v58, v58
    v_smfmac_f32_32x32x32_bf16 v[80:95], v[132:135], v[48:55], v118
    ds_read_b64_tr_b16 v[132:133], v142 offset:14592
    v_exp_f32 v59, v59
    v_exp_f32 v60, v60
    v_exp_f32 v61, v61
    v_exp_f32 v62, v62
    v_exp_f32 v63, v63
    v_exp_f32 v0, v0
    v_exp_f32 v1, v1
    v_smfmac_f32_32x32x32_bf16 v[80:95], v[136:139], v[56:63], v118
    s_waitcnt lgkmcnt(1)
    ds_read_b64_tr_b16 v[134:135], v142 offset:14720
    v_exp_f32 v2, v2
    v_exp_f32 v3, v3
    v_exp_f32 v4, v4
    v_mfma_f32_32x32x4_2b_bf16 v[32:63], v[116:117], v[106:107], 0
    v_exp_f32 v5, v5
    v_exp_f32 v6, v6
    v_exp_f32 v7, v7
    v_exp_f32 v8, v8
    v_exp_f32 v9, v9
    v_exp_f32 v10, v10
    v_exp_f32 v11, v11
    v_exp_f32 v12, v12
    v_smfmac_f32_32x32x32_bf16 v[64:79], v[124:127], v[0:7], v118
    ds_read_b32 v116, v120 offset:19456
    v_exp_f32 v13, v13
    v_exp_f32 v14, v14
    v_exp_f32 v15, v15
    v_exp_f32 v16, v16
    v_exp_f32 v17, v17
    v_smfmac_f32_32x32x32_bf16 v[64:79], v[128:131], v[8:15], v118
    s_waitcnt lgkmcnt(1)
    ds_read_b64_tr_b16 v[136:137], v143 offset:14592
    v_exp_f32 v18, v18
    v_exp_f32 v19, v19
    v_exp_f32 v20, v20
    v_mfma_f32_32x32x16_bf16 v[32:47], v[108:111], v[100:103], v[32:47]
    ds_read_b64_tr_b16 v[138:139], v143 offset:14720
    v_exp_f32 v21, v21
    v_exp_f32 v22, v22
    v_exp_f32 v23, v23
    v_mfma_f32_32x32x16_bf16 v[48:63], v[112:115], v[100:103], v[48:63]
    ds_read_b128 v[108:111], v119 offset:19456
    v_exp_f32 v24, v24
    v_exp_f32 v25, v25
    v_exp_f32 v26, v26
    v_smfmac_f32_32x32x32_bf16 v[64:79], v[132:135], v[16:23], v118
    s_waitcnt lgkmcnt(1)
    ds_read_b128 v[112:115], v119 offset:20480
    v_exp_f32 v27, v27
    v_exp_f32 v28, v28
    v_exp_f32 v29, v29
    v_exp_f32 v30, v30
    v_exp_f32 v31, v31
    v_exp_f32 v32, v32
    v_exp_f32 v33, v33
    v_smfmac_f32_32x32x32_bf16 v[64:79], v[136:139], v[24:31], v118
    v_exp_f32 v34, v34
    v_exp_f32 v35, v35
    v_exp_f32 v36, v36
    v_mfma_f32_32x32x4_2b_bf16 v[0:31], v[116:117], v[104:105], 0
    v_exp_f32 v37, v37
    v_exp_f32 v38, v38
    v_exp_f32 v39, v39
    v_exp_f32 v40, v40
    v_exp_f32 v41, v41
    v_exp_f32 v42, v42
    v_exp_f32 v43, v43
    v_exp_f32 v44, v44
    v_smfmac_f32_32x32x32_bf16 v[80:95], v[124:127], v[32:39], v118
    ds_read_b64_tr_b16 v[124:125], v140 offset:19456
    v_exp_f32 v45, v45
    v_exp_f32 v46, v46
    v_exp_f32 v47, v47
    v_exp_f32 v48, v48
    v_exp_f32 v49, v49
    v_smfmac_f32_32x32x32_bf16 v[80:95], v[128:131], v[40:47], v118
    s_waitcnt lgkmcnt(1)
    ds_read_b64_tr_b16 v[126:127], v140 offset:19584
    v_exp_f32 v50, v50
    v_exp_f32 v51, v51
    v_exp_f32 v52, v52
    v_mfma_f32_32x32x16_bf16 v[0:15], v[108:111], v[96:99], v[0:15]
    ds_read_b64_tr_b16 v[128:129], v141 offset:19456
    v_exp_f32 v53, v53
    v_exp_f32 v54, v54
    v_exp_f32 v55, v55
    v_mfma_f32_32x32x16_bf16 v[16:31], v[112:115], v[96:99], v[16:31]
    ds_read_b64_tr_b16 v[130:131], v141 offset:19584
    v_exp_f32 v56, v56
    v_exp_f32 v57, v57
    v_exp_f32 v58, v58
    v_smfmac_f32_32x32x32_bf16 v[80:95], v[132:135], v[48:55], v118
    ds_read_b64_tr_b16 v[132:133], v142 offset:19456
    v_exp_f32 v59, v59
    v_exp_f32 v60, v60
    v_exp_f32 v61, v61
    v_exp_f32 v62, v62
    v_exp_f32 v63, v63
    v_exp_f32 v0, v0
    v_exp_f32 v1, v1
    v_smfmac_f32_32x32x32_bf16 v[80:95], v[136:139], v[56:63], v118
    s_waitcnt lgkmcnt(1)
    ds_read_b64_tr_b16 v[134:135], v142 offset:19584
    v_exp_f32 v2, v2
    v_exp_f32 v3, v3
    v_exp_f32 v4, v4
    v_mfma_f32_32x32x4_2b_bf16 v[32:63], v[116:117], v[106:107], 0
    v_exp_f32 v5, v5
    v_exp_f32 v6, v6
    v_exp_f32 v7, v7
    v_exp_f32 v8, v8
    v_exp_f32 v9, v9
    v_exp_f32 v10, v10
    v_exp_f32 v11, v11
    v_exp_f32 v12, v12
    v_smfmac_f32_32x32x32_bf16 v[64:79], v[124:127], v[0:7], v118
    ds_read_b32 v116, v120 offset:24320
    v_exp_f32 v13, v13
    v_exp_f32 v14, v14
    v_exp_f32 v15, v15
    v_exp_f32 v16, v16
    v_exp_f32 v17, v17
    v_smfmac_f32_32x32x32_bf16 v[64:79], v[128:131], v[8:15], v118
    s_waitcnt lgkmcnt(1)
    ds_read_b64_tr_b16 v[136:137], v143 offset:19456
    v_exp_f32 v18, v18
    v_exp_f32 v19, v19
    v_exp_f32 v20, v20
    v_mfma_f32_32x32x16_bf16 v[32:47], v[108:111], v[100:103], v[32:47]
    ds_read_b64_tr_b16 v[138:139], v143 offset:19584
    v_exp_f32 v21, v21
    v_exp_f32 v22, v22
    v_exp_f32 v23, v23
    v_mfma_f32_32x32x16_bf16 v[48:63], v[112:115], v[100:103], v[48:63]
    ds_read_b128 v[108:111], v119 offset:24320
    v_exp_f32 v24, v24
    v_exp_f32 v25, v25
    v_exp_f32 v26, v26
    v_smfmac_f32_32x32x32_bf16 v[64:79], v[132:135], v[16:23], v118
    s_waitcnt lgkmcnt(1)
    ds_read_b128 v[112:115], v119 offset:25344
    v_exp_f32 v27, v27
    v_exp_f32 v28, v28
    v_exp_f32 v29, v29
    v_exp_f32 v30, v30
    v_exp_f32 v31, v31
    v_exp_f32 v32, v32
    v_exp_f32 v33, v33
    v_smfmac_f32_32x32x32_bf16 v[64:79], v[136:139], v[24:31], v118
    v_exp_f32 v34, v34
    v_exp_f32 v35, v35
    v_exp_f32 v36, v36
    v_mfma_f32_32x32x4_2b_bf16 v[0:31], v[116:117], v[104:105], 0
    v_exp_f32 v37, v37
    v_exp_f32 v38, v38
    v_exp_f32 v39, v39
    v_exp_f32 v40, v40
    v_exp_f32 v41, v41
    v_exp_f32 v42, v42
    v_exp_f32 v43, v43
    v_exp_f32 v44, v44
    v_smfmac_f32_32x32x32_bf16 v[80:95], v[124:127], v[32:39], v118
    ds_read_b64_tr_b16 v[124:125], v140 offset:24320
    v_exp_f32 v45, v45
    v_exp_f32 v46, v46
    v_exp_f32 v47, v47
    v_exp_f32 v48, v48
    v_exp_f32 v49, v49
    v_smfmac_f32_32x32x32_bf16 v[80:95], v[128:131], v[40:47], v118
    s_waitcnt lgkmcnt(1)
    ds_read_b64_tr_b16 v[126:127], v140 offset:24448
    v_exp_f32 v50, v50
    v_exp_f32 v51, v51
    v_exp_f32 v52, v52
    v_mfma_f32_32x32x16_bf16 v[0:15], v[108:111], v[96:99], v[0:15]
    ds_read_b64_tr_b16 v[128:129], v141 offset:24320
    v_exp_f32 v53, v53
    v_exp_f32 v54, v54
    v_exp_f32 v55, v55
    v_mfma_f32_32x32x16_bf16 v[16:31], v[112:115], v[96:99], v[16:31]
    ds_read_b64_tr_b16 v[130:131], v141 offset:24448
    v_exp_f32 v56, v56
    v_exp_f32 v57, v57
    v_exp_f32 v58, v58
    v_smfmac_f32_32x32x32_bf16 v[80:95], v[132:135], v[48:55], v118
    ds_read_b64_tr_b16 v[132:133], v142 offset:24320
    v_exp_f32 v59, v59
    v_exp_f32 v60, v60
    v_exp_f32 v61, v61
    v_exp_f32 v62, v62
    v_exp_f32 v63, v63
    v_exp_f32 v0, v0
    v_exp_f32 v1, v1
    v_smfmac_f32_32x32x32_bf16 v[80:95], v[136:139], v[56:63], v118
    s_waitcnt lgkmcnt(1)
    ds_read_b64_tr_b16 v[134:135], v142 offset:24448
    v_exp_f32 v2, v2
    v_exp_f32 v3, v3
    v_exp_f32 v4, v4
    v_mfma_f32_32x32x4_2b_bf16 v[32:63], v[116:117], v[106:107], 0
    v_exp_f32 v5, v5
    v_exp_f32 v6, v6
    v_exp_f32 v7, v7
    v_exp_f32 v8, v8
    v_exp_f32 v9, v9
    v_exp_f32 v10, v10
    v_exp_f32 v11, v11
    v_exp_f32 v12, v12
    v_smfmac_f32_32x32x32_bf16 v[64:79], v[124:127], v[0:7], v118
    ds_read_b32 v116, v120 offset:29184
    v_exp_f32 v13, v13
    v_exp_f32 v14, v14
    v_exp_f32 v15, v15
    v_exp_f32 v16, v16
    v_exp_f32 v17, v17
    v_smfmac_f32_32x32x32_bf16 v[64:79], v[128:131], v[8:15], v118
    s_waitcnt lgkmcnt(1)
    ds_read_b64_tr_b16 v[136:137], v143 offset:24320
    v_exp_f32 v18, v18
    v_exp_f32 v19, v19
    v_exp_f32 v20, v20
    v_mfma_f32_32x32x16_bf16 v[32:47], v[108:111], v[100:103], v[32:47]
    ds_read_b64_tr_b16 v[138:139], v143 offset:24448
    v_exp_f32 v21, v21
    v_exp_f32 v22, v22
    v_exp_f32 v23, v23
    v_mfma_f32_32x32x16_bf16 v[48:63], v[112:115], v[100:103], v[48:63]
    ds_read_b128 v[108:111], v119 offset:29184
    v_exp_f32 v24, v24
    v_exp_f32 v25, v25
    v_exp_f32 v26, v26
    v_smfmac_f32_32x32x32_bf16 v[64:79], v[132:135], v[16:23], v118
    s_waitcnt lgkmcnt(1)
    ds_read_b128 v[112:115], v119 offset:30208
    v_exp_f32 v27, v27
    v_exp_f32 v28, v28
    v_exp_f32 v29, v29
    v_exp_f32 v30, v30
    v_exp_f32 v31, v31
    v_exp_f32 v32, v32
    v_exp_f32 v33, v33
    v_smfmac_f32_32x32x32_bf16 v[64:79], v[136:139], v[24:31], v118
    v_exp_f32 v34, v34
    v_exp_f32 v35, v35
    v_exp_f32 v36, v36
    v_mfma_f32_32x32x4_2b_bf16 v[0:31], v[116:117], v[104:105], 0
    v_exp_f32 v37, v37
    v_exp_f32 v38, v38
    v_exp_f32 v39, v39
    v_exp_f32 v40, v40
    v_exp_f32 v41, v41
    v_exp_f32 v42, v42
    v_exp_f32 v43, v43
    v_exp_f32 v44, v44
    v_smfmac_f32_32x32x32_bf16 v[80:95], v[124:127], v[32:39], v118
    ds_read_b64_tr_b16 v[124:125], v140 offset:29184
    v_exp_f32 v45, v45
    v_exp_f32 v46, v46
    v_exp_f32 v47, v47
    v_exp_f32 v48, v48
    v_exp_f32 v49, v49
    v_smfmac_f32_32x32x32_bf16 v[80:95], v[128:131], v[40:47], v118
    s_waitcnt lgkmcnt(1)
    ds_read_b64_tr_b16 v[126:127], v140 offset:29312
    v_exp_f32 v50, v50
    v_exp_f32 v51, v51
    v_exp_f32 v52, v52
    v_mfma_f32_32x32x16_bf16 v[0:15], v[108:111], v[96:99], v[0:15]
    ds_read_b64_tr_b16 v[128:129], v141 offset:29184
    v_exp_f32 v53, v53
    v_exp_f32 v54, v54
    v_exp_f32 v55, v55
    v_mfma_f32_32x32x16_bf16 v[16:31], v[112:115], v[96:99], v[16:31]
    ds_read_b64_tr_b16 v[130:131], v141 offset:29312
    v_exp_f32 v56, v56
    v_exp_f32 v57, v57
    v_exp_f32 v58, v58
    v_smfmac_f32_32x32x32_bf16 v[80:95], v[132:135], v[48:55], v118
    ds_read_b64_tr_b16 v[132:133], v142 offset:29184
    v_exp_f32 v59, v59
    v_exp_f32 v60, v60
    v_exp_f32 v61, v61
    v_exp_f32 v62, v62
    v_exp_f32 v63, v63
    v_exp_f32 v0, v0
    v_exp_f32 v1, v1
    v_smfmac_f32_32x32x32_bf16 v[80:95], v[136:139], v[56:63], v118
    s_waitcnt lgkmcnt(1)
    ds_read_b64_tr_b16 v[134:135], v142 offset:29312
    v_exp_f32 v2, v2
    v_exp_f32 v3, v3
    v_exp_f32 v4, v4
    v_mfma_f32_32x32x4_2b_bf16 v[32:63], v[116:117], v[106:107], 0
    v_exp_f32 v5, v5
    v_exp_f32 v6, v6
    v_exp_f32 v7, v7
    v_exp_f32 v8, v8
    v_exp_f32 v9, v9
    v_exp_f32 v10, v10
    v_exp_f32 v11, v11
    v_exp_f32 v12, v12
    v_smfmac_f32_32x32x32_bf16 v[64:79], v[124:127], v[0:7], v118
    ds_read_b32 v116, v120 offset:34048
    v_exp_f32 v13, v13
    v_exp_f32 v14, v14
    v_exp_f32 v15, v15
    v_exp_f32 v16, v16
    v_exp_f32 v17, v17
    v_smfmac_f32_32x32x32_bf16 v[64:79], v[128:131], v[8:15], v118
    s_waitcnt lgkmcnt(1)
    ds_read_b64_tr_b16 v[136:137], v143 offset:29184
    v_exp_f32 v18, v18
    v_exp_f32 v19, v19
    v_exp_f32 v20, v20
    v_mfma_f32_32x32x16_bf16 v[32:47], v[108:111], v[100:103], v[32:47]
    ds_read_b64_tr_b16 v[138:139], v143 offset:29312
    v_exp_f32 v21, v21
    v_exp_f32 v22, v22
    v_exp_f32 v23, v23
    v_mfma_f32_32x32x16_bf16 v[48:63], v[112:115], v[100:103], v[48:63]
    ds_read_b128 v[108:111], v119 offset:34048
    v_exp_f32 v24, v24
    v_exp_f32 v25, v25
    v_exp_f32 v26, v26
    v_smfmac_f32_32x32x32_bf16 v[64:79], v[132:135], v[16:23], v118
    s_waitcnt lgkmcnt(1)
    ds_read_b128 v[112:115], v119 offset:35072
    v_exp_f32 v27, v27
    v_exp_f32 v28, v28
    v_exp_f32 v29, v29
    v_exp_f32 v30, v30
    v_exp_f32 v31, v31
    v_exp_f32 v32, v32
    v_exp_f32 v33, v33
    v_smfmac_f32_32x32x32_bf16 v[64:79], v[136:139], v[24:31], v118
    v_exp_f32 v34, v34
    v_exp_f32 v35, v35
    v_exp_f32 v36, v36
    v_mfma_f32_32x32x4_2b_bf16 v[0:31], v[116:117], v[104:105], 0
    v_exp_f32 v37, v37
    v_exp_f32 v38, v38
    v_exp_f32 v39, v39
    v_exp_f32 v40, v40
    v_exp_f32 v41, v41
    v_exp_f32 v42, v42
    v_exp_f32 v43, v43
    v_exp_f32 v44, v44
    v_smfmac_f32_32x32x32_bf16 v[80:95], v[124:127], v[32:39], v118
    ds_read_b64_tr_b16 v[124:125], v140 offset:34048
    v_exp_f32 v45, v45
    v_exp_f32 v46, v46
    v_exp_f32 v47, v47
    v_exp_f32 v48, v48
    v_exp_f32 v49, v49
    v_smfmac_f32_32x32x32_bf16 v[80:95], v[128:131], v[40:47], v118
    s_waitcnt lgkmcnt(1)
    ds_read_b64_tr_b16 v[126:127], v140 offset:34176
    v_exp_f32 v50, v50
    v_exp_f32 v51, v51
    v_exp_f32 v52, v52
    v_mfma_f32_32x32x16_bf16 v[0:15], v[108:111], v[96:99], v[0:15]
    ds_read_b64_tr_b16 v[128:129], v141 offset:34048
    v_exp_f32 v53, v53
    v_exp_f32 v54, v54
    v_exp_f32 v55, v55
    v_mfma_f32_32x32x16_bf16 v[16:31], v[112:115], v[96:99], v[16:31]
    ds_read_b64_tr_b16 v[130:131], v141 offset:34176
    v_exp_f32 v56, v56
    v_exp_f32 v57, v57
    v_exp_f32 v58, v58
    v_smfmac_f32_32x32x32_bf16 v[80:95], v[132:135], v[48:55], v118
    ds_read_b64_tr_b16 v[132:133], v142 offset:34048
    v_exp_f32 v59, v59
    v_exp_f32 v60, v60
    v_exp_f32 v61, v61
    v_exp_f32 v62, v62
    v_exp_f32 v63, v63
    v_exp_f32 v0, v0
    v_exp_f32 v1, v1
    v_smfmac_f32_32x32x32_bf16 v[80:95], v[136:139], v[56:63], v118
    s_waitcnt lgkmcnt(1)
    ds_read_b64_tr_b16 v[134:135], v142 offset:34176
    v_exp_f32 v2, v2
    v_exp_f32 v3, v3
    v_exp_f32 v4, v4
    v_mfma_f32_32x32x4_2b_bf16 v[32:63], v[116:117], v[106:107], 0
    s_cmp_lt_u32 s3, 4
    s_cbranch_scc0 .Lpr15
    s_setprio 0
.Lpr15:
    v_exp_f32 v5, v5
    v_exp_f32 v6, v6
    v_exp_f32 v7, v7
    v_exp_f32 v8, v8
    v_exp_f32 v9, v9
    v_exp_f32 v10, v10
    v_exp_f32 v11, v11
    v_exp_f32 v12, v12
    v_smfmac_f32_32x32x32_bf16 v[64:79], v[124:127], v[0:7], v118
    ds_read_b32 v116, v120 offset:38912
    v_exp_f32 v13, v13
    v_exp_f32 v14, v14
    v_exp_f32 v15, v15
    v_exp_f32 v16, v16
    v_exp_f32 v17, v17
    v_smfmac_f32_32x32x32_bf16 v[64:79], v[128:131], v[8:15], v118
    s_waitcnt lgkmcnt(1)
    ds_read_b64_tr_b16 v[136:137], v143 offset:34048
    v_exp_f32 v18, v18
    v_exp_f32 v19, v19
    v_exp_f32 v20, v20
    v_mfma_f32_32x32x16_bf16 v[32:47], v[108:111], v[100:103], v[32:47]
    ds_read_b64_tr_b16 v[138:139], v143 offset:34176
    v_exp_f32 v21, v21
    v_exp_f32 v22, v22
    v_exp_f32 v23, v23
    v_mfma_f32_32x32x16_bf16 v[48:63], v[112:115], v[100:103], v[48:63]
    ds_read_b128 v[108:111], v119 offset:38912
    v_exp_f32 v24, v24
    v_exp_f32 v25, v25
    v_exp_f32 v26, v26
    v_smfmac_f32_32x32x32_bf16 v[64:79], v[132:135], v[16:23], v118
    s_waitcnt lgkmcnt(1)
    ds_read_b128 v[112:115], v119 offset:39936
    v_exp_f32 v27, v27
    v_exp_f32 v28, v28
    v_exp_f32 v29, v29
    v_exp_f32 v30, v30
    v_exp_f32 v31, v31
    v_exp_f32 v32, v32
    v_exp_f32 v33, v33
    v_smfmac_f32_32x32x32_bf16 v[64:79], v[136:139], v[24:31], v118
    v_exp_f32 v34, v34
    v_exp_f32 v35, v35
    v_exp_f32 v36, v36
    v_mfma_f32_32x32x4_2b_bf16 v[0:31], v[116:117], v[104:105], 0
    v_exp_f32 v37, v37
    v_exp_f32 v38, v38
    v_exp_f32 v39, v39
    v_exp_f32 v40, v40
    v_exp_f32 v41, v41
    v_exp_f32 v42, v42
    v_exp_f32 v43, v43
    v_exp_f32 v44, v44
    v_smfmac_f32_32x32x32_bf16 v[80:95], v[124:127], v[32:39], v118
    ds_read_b64_tr_b16 v[124:125], v140 offset:38912
    v_exp_f32 v45, v45
    v_exp_f32 v46, v46
    v_exp_f32 v47, v47
    v_exp_f32 v48, v48
    v_exp_f32 v49, v49
    v_smfmac_f32_32x32x32_bf16 v[80:95], v[128:131], v[40:47], v118
    s_waitcnt lgkmcnt(1)
    ds_read_b64_tr_b16 v[126:127], v140 offset:39040
    v_exp_f32 v50, v50
    v_exp_f32 v51, v51
    v_exp_f32 v52, v52
    v_mfma_f32_32x32x16_bf16 v[0:15], v[108:111], v[96:99], v[0:15]
    ds_read_b64_tr_b16 v[128:129], v141 offset:38912
    v_exp_f32 v53, v53
    v_exp_f32 v54, v54
    v_exp_f32 v55, v55
    v_mfma_f32_32x32x16_bf16 v[16:31], v[112:115], v[96:99], v[16:31]
    ds_read_b64_tr_b16 v[130:131], v141 offset:39040
    v_exp_f32 v56, v56
    v_exp_f32 v57, v57
    v_exp_f32 v58, v58
    v_smfmac_f32_32x32x32_bf16 v[80:95], v[132:135], v[48:55], v118
    ds_read_b64_tr_b16 v[132:133], v142 offset:38912
    v_exp_f32 v59, v59
    v_exp_f32 v60, v60
    v_exp_f32 v61, v61
    v_exp_f32 v62, v62
    v_exp_f32 v63, v63
    v_add_u32 v119, 38912, v119
    v_add_u32 v120, 38912, v120
    v_add_u32 v140, 38912, v140
    v_add_u32 v141, 38912, v141
    v_add_u32 v142, 38912, v142
    v_add_u32 v143, 38912, v143
    s_sub_u32 s54, s54, 1
    s_cmp_lg_u32 s54, 0
    s_cbranch_scc1 .Lattn_loop
.Lattn_done:
    v_smfmac_f32_32x32x32_bf16 v[80:95], v[136:139], v[56:63], v118
    buffer_load_dword v254, v250, s[8:11], s20 offen sc1
    s_waitcnt lgkmcnt(0)
    v_mov_b32 v4, v74
    v_lshlrev_b32 v2, 4, v252
    v_lshlrev_b32 v3, 2, v252
    v_permlane32_swap_b32 v74, v4
    s_lshl_b32 s56, s48, 16
    s_lshl_b32 s57, s49, 11
    s_add_u32 s56, s56, s57
    s_add_u32 s56, s56, 15728640
    v_rcp_f32 v0, v74
    s_lshl_b32 s57, s48, 13
    s_lshl_b32 s58, s49, 8
    s_add_u32 s57, s57, s58
    s_add_u32 s57, s57, 19922944
    v_mov_b32 v4, v90
    v_mul_f32 v64, v0, v64
    v_mul_f32 v65, v0, v65
    v_mul_f32 v66, v0, v66
    v_mul_f32 v67, v0, v67
    v_mul_f32 v68, v0, v68
    v_mul_f32 v69, v0, v69
    v_mul_f32 v70, v0, v70
    v_mul_f32 v71, v0, v71
    v_mul_f32 v72, v0, v72
    v_mul_f32 v73, v0, v73
    v_permlane32_swap_b32 v90, v4
    v_cvt_pk_bf16_f32 v8, v64, v65
    v_cvt_pk_bf16_f32 v9, v66, v67
    v_cvt_pk_bf16_f32 v10, v68, v69
    v_cvt_pk_bf16_f32 v11, v70, v71
    v_cvt_pk_bf16_f32 v12, v72, v73
    v_rcp_f32 v1, v90
    buffer_store_dwordx4 v[8:11], v2, s[8:11], s56 offen sc1
    v_mul_f32 v80, v1, v80
    v_mul_f32 v81, v1, v81
    v_mul_f32 v82, v1, v82
    v_mul_f32 v83, v1, v83
    v_mul_f32 v84, v1, v84
    v_mul_f32 v85, v1, v85
    v_mul_f32 v86, v1, v86
    v_mul_f32 v87, v1, v87
    v_mul_f32 v88, v1, v88
    v_mul_f32 v89, v1, v89
    v_cvt_pk_bf16_f32 v16, v80, v81
    v_cvt_pk_bf16_f32 v17, v82, v83
    v_cvt_pk_bf16_f32 v18, v84, v85
    v_cvt_pk_bf16_f32 v19, v86, v87
    v_cvt_pk_bf16_f32 v20, v88, v89
    buffer_store_dwordx4 v[16:19], v2, s[8:11], s56 offen offset:1024 sc1
    v_mov_b32 v0, 0
    v_permlane32_swap_b32 v12, v20
    v_mov_b32 v1, 0
    buffer_store_dword v12, v3, s[8:11], s57 offen sc1
    v_fmac_f32 v0, 0, v64
    v_fmac_f32 v1, 0, v80
    v_fmac_f32 v0, 0, v65
    v_fmac_f32 v1, 0, v81
    v_fmac_f32 v0, 0, v66
    v_fmac_f32 v1, 0, v82
    v_fmac_f32 v0, 0, v67
    v_fmac_f32 v1, 0, v83
    v_fmac_f32 v0, 0, v68
    v_fmac_f32 v1, 0, v84
    v_fmac_f32 v0, 0, v69
    v_fmac_f32 v1, 0, v85
    v_fmac_f32 v0, 0, v70
    v_fmac_f32 v1, 0, v86
    v_fmac_f32 v0, 0, v71
    v_fmac_f32 v1, 0, v87
    v_fmac_f32 v0, 0, v72
    v_fmac_f32 v1, 0, v88
    v_fmac_f32 v0, 0, v73
    v_fmac_f32 v1, 0, v89
    v_add_f32 v0, v0, v74
    v_add_f32 v1, v1, v90
    s_mov_b32 s56, 0x5d800000
    s_mov_b32 s57, 0x33800000
    v_cmp_nge_f32 s[58:59], s56, v0
    v_cmp_nle_f32 s[60:61], s57, v0
    v_cmp_nge_f32 s[62:63], s56, v1
    v_cmp_nle_f32 s[64:65], s57, v1
    s_or_b64 s[58:59], s[58:59], s[60:61]
    s_or_b64 s[62:63], s[62:63], s[64:65]
    s_or_b64 s[58:59], s[58:59], s[62:63]
    s_cselect_b32 s56, 1, 0
    s_cmp_gt_u32 s56, s55
    s_cbranch_scc1 .Lattn_fallback
    v_and_b32 v246, 15, v252
    v_lshrrev_b32 v247, 4, v252
    v_lshrrev_b32 v3, 1, v247
    v_lshlrev_b32 v3, 16, v3
    v_and_b32 v4, 1, v247
    v_lshl_add_u32 v3, v4, 9, v3
    v_lshl_add_u32 v248, v246, 4, v3
    s_lshr_b32 s61, s3, 2
    s_lshl_b32 s61, s61, 4
    s_and_b32 s62, s3, 3
    s_add_u32 s61, s61, s62
    s_lshl_b32 s58, s61, 17
    s_lshl_b32 s59, s50, 11
    s_add_u32 s58, s58, s59
    s_add_u32 s58, s58, 15728640
    s_add_u32 s62, s4, 1
    s_and_b32 s62, s62, 3
    s_lshl_b32 s62, s62, 19
    s_add_u32 s62, s62, s58
    s_add_u32 s63, s4, 2
    s_and_b32 s63, s63, 3
    s_lshl_b32 s63, s63, 19
    s_add_u32 s63, s63, s58
    s_add_u32 s64, s4, 3
    s_and_b32 s64, s64, 3
    s_lshl_b32 s64, s64, 19
    s_add_u32 s64, s64, s58
    s_add_u32 s65, s4, 4
    s_and_b32 s65, s65, 3
    s_lshl_b32 s65, s65, 19
    s_add_u32 s65, s65, s58
    s_and_b32 s66, s4, 3
    s_lshl_b32 s66, s66, 1
    s_lshl_b32 s67, 3, s66
    s_andn2_b32 s67, 0xff, s67
    v_mov_b32 v253, 1
    s_waitcnt vmcnt(3)
    v_cmp_ne_u32 vcc, 0, v254
    s_and_b32 s68, vcc_lo, s67
    s_cmp_eq_u32 s68, s67
    s_cbranch_scc0 .Lout_dyn
    buffer_load_dwordx4 v[96:99], v248, s[8:11], s62 offen offset:0 sc1
    buffer_load_dwordx4 v[100:103], v248, s[8:11], s62 offen offset:256 sc1
    buffer_load_dwordx4 v[104:107], v248, s[8:11], s62 offen offset:1024 sc1
    buffer_load_dwordx4 v[108:111], v248, s[8:11], s62 offen offset:1280 sc1
    buffer_load_dwordx4 v[112:115], v248, s[8:11], s63 offen offset:0 sc1
    buffer_load_dwordx4 v[116:119], v248, s[8:11], s63 offen offset:256 sc1
    buffer_load_dwordx4 v[120:123], v248, s[8:11], s63 offen offset:1024 sc1
    buffer_load_dwordx4 v[124:127], v248, s[8:11], s63 offen offset:1280 sc1
    v_lshlrev_b32 v3, 16, v247
    v_lshl_add_u32 v249, v246, 2, v3
    v_mov_b32 v4, 0
    s_lshl_b32 s59, s61, 14
    s_lshl_b32 s60, s50, 8
    s_add_u32 s59, s59, s60
    s_add_u32 s59, s59, 19922944
    s_add_u32 s61, s59, 8192
    s_waitcnt vmcnt(8)
    s_mov_b64 exec, 1
    buffer_store_dword v253, v4, s[8:11], s21 offen sc1
    s_mov_b64 exec, -1
    s_barrier
    s_waitcnt vmcnt(5)
    s_branch .Lout_go
.Lout_dyn:
    v_lshlrev_b32 v3, 16, v247
    v_lshl_add_u32 v249, v246, 2, v3
    v_mov_b32 v4, 0
    s_lshl_b32 s59, s61, 14
    s_lshl_b32 s60, s50, 8
    s_add_u32 s59, s59, s60
    s_add_u32 s59, s59, 19922944
    s_add_u32 s61, s59, 8192
    s_waitcnt vmcnt(0)
    s_mov_b64 exec, 1
    buffer_store_dword v253, v4, s[8:11], s21 offen sc1
    s_mov_b64 exec, -1
    s_barrier
    s_mov_b32 s70, 3000000
    s_mov_b32 s68, s67
    s_mov_b32 s69, 0
.Lpoll16:
    buffer_load_dword v254, v250, s[8:11], s20 offen sc1
    s_waitcnt vmcnt(0)
    v_cmp_ne_u32 vcc, 0, v254
    s_and_b64 vcc, vcc, s[68:69]
    s_cmp_eq_u64 vcc, s[68:69]
    s_cbranch_scc1 .Lpolld17
    s_sub_u32 s70, s70, 1
    s_cmp_lg_u32 s70, 0
    s_cbranch_scc1 .Lpoll16
.Lpolld17:
    buffer_load_dwordx4 v[96:99], v248, s[8:11], s62 offen offset:0 sc1
    buffer_load_dwordx4 v[100:103], v248, s[8:11], s62 offen offset:256 sc1
    buffer_load_dwordx4 v[104:107], v248, s[8:11], s62 offen offset:1024 sc1
    buffer_load_dwordx4 v[108:111], v248, s[8:11], s62 offen offset:1280 sc1
    buffer_load_dwordx4 v[112:115], v248, s[8:11], s63 offen offset:0 sc1
    buffer_load_dwordx4 v[116:119], v248, s[8:11], s63 offen offset:256 sc1
    buffer_load_dwordx4 v[120:123], v248, s[8:11], s63 offen offset:1024 sc1
    buffer_load_dwordx4 v[124:127], v248, s[8:11], s63 offen offset:1280 sc1
    s_waitcnt vmcnt(4)
.Lout_go:
    buffer_load_dwordx4 v[128:131], v248, s[8:11], s64 offen offset:0 sc1
    buffer_load_dwordx4 v[132:135], v248, s[8:11], s64 offen offset:256 sc1
    buffer_load_dwordx4 v[136:139], v248, s[8:11], s64 offen offset:1024 sc1
    buffer_load_dwordx4 v[140:143], v248, s[8:11], s64 offen offset:1280 sc1
    buffer_load_dword v254, v250, s[8:11], s20 offen sc1
    v_mfma_f32_16x16x32_bf16 v[0:3], v[152:155], v[96:99], 0
    v_mfma_f32_16x16x32_bf16 v[4:7], v[156:159], v[96:99], 0
    v_mfma_f32_16x16x32_bf16 v[8:11], v[160:163], v[96:99], 0
    v_mfma_f32_16x16x32_bf16 v[12:15], v[164:167], v[96:99], 0
    v_mfma_f32_16x16x32_bf16 v[16:19], v[168:171], v[96:99], 0
    v_mfma_f32_16x16x32_bf16 v[20:23], v[152:155], v[100:103], 0
    v_mfma_f32_16x16x32_bf16 v[24:27], v[156:159], v[100:103], 0
    v_mfma_f32_16x16x32_bf16 v[28:31], v[160:163], v[100:103], 0
    v_mfma_f32_16x16x32_bf16 v[32:35], v[164:167], v[100:103], 0
    v_mfma_f32_16x16x32_bf16 v[36:39], v[168:171], v[100:103], 0
    v_mfma_f32_16x16x32_bf16 v[40:43], v[152:155], v[104:107], 0
    v_mfma_f32_16x16x32_bf16 v[44:47], v[156:159], v[104:107], 0
    v_mfma_f32_16x16x32_bf16 v[48:51], v[160:163], v[104:107], 0
    v_mfma_f32_16x16x32_bf16 v[52:55], v[164:167], v[104:107], 0
    v_mfma_f32_16x16x32_bf16 v[56:59], v[168:171], v[104:107], 0
    v_mfma_f32_16x16x32_bf16 v[60:63], v[152:155], v[108:111], 0
    v_mfma_f32_16x16x32_bf16 v[64:67], v[156:159], v[108:111], 0
    v_mfma_f32_16x16x32_bf16 v[68:71], v[160:163], v[108:111], 0
    v_mfma_f32_16x16x32_bf16 v[72:75], v[164:167], v[108:111], 0
    v_mfma_f32_16x16x32_bf16 v[76:79], v[168:171], v[108:111], 0
    s_waitcnt vmcnt(5)
    v_mfma_f32_16x16x32_bf16 v[0:3], v[172:175], v[112:115], v[0:3]
    v_mfma_f32_16x16x32_bf16 v[4:7], v[176:179], v[112:115], v[4:7]
    v_mfma_f32_16x16x32_bf16 v[8:11], v[180:183], v[112:115], v[8:11]
    v_mfma_f32_16x16x32_bf16 v[12:15], v[184:187], v[112:115], v[12:15]
    v_mfma_f32_16x16x32_bf16 v[16:19], v[188:191], v[112:115], v[16:19]
    v_mfma_f32_16x16x32_bf16 v[20:23], v[172:175], v[116:119], v[20:23]
    v_mfma_f32_16x16x32_bf16 v[24:27], v[176:179], v[116:119], v[24:27]
    v_mfma_f32_16x16x32_bf16 v[28:31], v[180:183], v[116:119], v[28:31]
    v_mfma_f32_16x16x32_bf16 v[32:35], v[184:187], v[116:119], v[32:35]
    v_mfma_f32_16x16x32_bf16 v[36:39], v[188:191], v[116:119], v[36:39]
    v_mfma_f32_16x16x32_bf16 v[40:43], v[172:175], v[120:123], v[40:43]
    v_mfma_f32_16x16x32_bf16 v[44:47], v[176:179], v[120:123], v[44:47]
    v_mfma_f32_16x16x32_bf16 v[48:51], v[180:183], v[120:123], v[48:51]
    v_mfma_f32_16x16x32_bf16 v[52:55], v[184:187], v[120:123], v[52:55]
    v_mfma_f32_16x16x32_bf16 v[56:59], v[188:191], v[120:123], v[56:59]
    v_mfma_f32_16x16x32_bf16 v[60:63], v[172:175], v[124:127], v[60:63]
    v_mfma_f32_16x16x32_bf16 v[64:67], v[176:179], v[124:127], v[64:67]
    v_mfma_f32_16x16x32_bf16 v[68:71], v[180:183], v[124:127], v[68:71]
    v_mfma_f32_16x16x32_bf16 v[72:75], v[184:187], v[124:127], v[72:75]
    v_mfma_f32_16x16x32_bf16 v[76:79], v[188:191], v[124:127], v[76:79]
    s_mov_b32 s70, 3000000
    s_mov_b32 s68, 0xff
    s_mov_b32 s69, 0x0
    s_branch .Lpolll21
.Lpoll19:
    buffer_load_dword v254, v250, s[8:11], s20 offen sc1
.Lpolll21:
    s_waitcnt vmcnt(0)
    v_cmp_ne_u32 vcc, 0, v254
    s_and_b64 vcc, vcc, s[68:69]
    s_cmp_eq_u64 vcc, s[68:69]
    s_cbranch_scc1 .Lpolld20
    s_sub_u32 s70, s70, 1
    s_cmp_lg_u32 s70, 0
    s_cbranch_scc1 .Lpoll19
.Lpolld20:
    buffer_load_dwordx4 v[80:83], v248, s[8:11], s65 offen offset:0 sc1
    buffer_load_dwordx4 v[84:87], v248, s[8:11], s65 offen offset:256 sc1
    buffer_load_dwordx4 v[88:91], v248, s[8:11], s65 offen offset:1024 sc1
    buffer_load_dwordx4 v[92:95], v248, s[8:11], s65 offen offset:1280 sc1
    buffer_load_dword v144, v249, s[8:11], s59 offen offset:0 sc1
    buffer_load_dword v145, v249, s[8:11], s61 offen offset:0 sc1
    buffer_load_dword v146, v249, s[8:11], s59 offen offset:64 sc1
    buffer_load_dword v147, v249, s[8:11], s61 offen offset:64 sc1
    buffer_load_dword v148, v249, s[8:11], s59 offen offset:128 sc1
    buffer_load_dword v149, v249, s[8:11], s61 offen offset:128 sc1
    buffer_load_dword v150, v249, s[8:11], s59 offen offset:192 sc1
    buffer_load_dword v151, v249, s[8:11], s61 offen offset:192 sc1
    v_mfma_f32_16x16x32_bf16 v[0:3], v[192:195], v[128:131], v[0:3]
    v_mfma_f32_16x16x32_bf16 v[4:7], v[196:199], v[128:131], v[4:7]
    v_mfma_f32_16x16x32_bf16 v[8:11], v[200:203], v[128:131], v[8:11]
    v_mfma_f32_16x16x32_bf16 v[12:15], v[204:207], v[128:131], v[12:15]
    v_mfma_f32_16x16x32_bf16 v[16:19], v[208:211], v[128:131], v[16:19]
    v_mfma_f32_16x16x32_bf16 v[20:23], v[192:195], v[132:135], v[20:23]
    v_mfma_f32_16x16x32_bf16 v[24:27], v[196:199], v[132:135], v[24:27]
    v_mfma_f32_16x16x32_bf16 v[28:31], v[200:203], v[132:135], v[28:31]
    v_mfma_f32_16x16x32_bf16 v[32:35], v[204:207], v[132:135], v[32:35]
    v_mfma_f32_16x16x32_bf16 v[36:39], v[208:211], v[132:135], v[36:39]
    v_mfma_f32_16x16x32_bf16 v[40:43], v[192:195], v[136:139], v[40:43]
    v_mfma_f32_16x16x32_bf16 v[44:47], v[196:199], v[136:139], v[44:47]
    v_mfma_f32_16x16x32_bf16 v[48:51], v[200:203], v[136:139], v[48:51]
    v_mfma_f32_16x16x32_bf16 v[52:55], v[204:207], v[136:139], v[52:55]
    v_mfma_f32_16x16x32_bf16 v[56:59], v[208:211], v[136:139], v[56:59]
    v_mfma_f32_16x16x32_bf16 v[60:63], v[192:195], v[140:143], v[60:63]
    v_mfma_f32_16x16x32_bf16 v[64:67], v[196:199], v[140:143], v[64:67]
    v_mfma_f32_16x16x32_bf16 v[68:71], v[200:203], v[140:143], v[68:71]
    v_mfma_f32_16x16x32_bf16 v[72:75], v[204:207], v[140:143], v[72:75]
    v_mfma_f32_16x16x32_bf16 v[76:79], v[208:211], v[140:143], v[76:79]
    s_waitcnt vmcnt(8)
    v_mfma_f32_16x16x32_bf16 v[0:3], v[212:215], v[80:83], v[0:3]
    v_mfma_f32_16x16x32_bf16 v[4:7], v[216:219], v[80:83], v[4:7]
    v_mfma_f32_16x16x32_bf16 v[8:11], v[220:223], v[80:83], v[8:11]
    v_mfma_f32_16x16x32_bf16 v[12:15], v[224:227], v[80:83], v[12:15]
    v_mfma_f32_16x16x32_bf16 v[16:19], v[228:231], v[80:83], v[16:19]
    v_mfma_f32_16x16x32_bf16 v[20:23], v[212:215], v[84:87], v[20:23]
    v_mfma_f32_16x16x32_bf16 v[24:27], v[216:219], v[84:87], v[24:27]
    v_mfma_f32_16x16x32_bf16 v[28:31], v[220:223], v[84:87], v[28:31]
    v_mfma_f32_16x16x32_bf16 v[32:35], v[224:227], v[84:87], v[32:35]
    v_mfma_f32_16x16x32_bf16 v[36:39], v[228:231], v[84:87], v[36:39]
    v_mfma_f32_16x16x32_bf16 v[40:43], v[212:215], v[88:91], v[40:43]
    v_mfma_f32_16x16x32_bf16 v[44:47], v[216:219], v[88:91], v[44:47]
    v_mfma_f32_16x16x32_bf16 v[48:51], v[220:223], v[88:91], v[48:51]
    v_mfma_f32_16x16x32_bf16 v[52:55], v[224:227], v[88:91], v[52:55]
    v_mfma_f32_16x16x32_bf16 v[56:59], v[228:231], v[88:91], v[56:59]
    v_mfma_f32_16x16x32_bf16 v[60:63], v[212:215], v[92:95], v[60:63]
    v_mfma_f32_16x16x32_bf16 v[64:67], v[216:219], v[92:95], v[64:67]
    v_mfma_f32_16x16x32_bf16 v[68:71], v[220:223], v[92:95], v[68:71]
    v_mfma_f32_16x16x32_bf16 v[72:75], v[224:227], v[92:95], v[72:75]
    v_mfma_f32_16x16x32_bf16 v[76:79], v[228:231], v[92:95], v[76:79]
.Lout_extra:
    s_mul_i32 s58, s3, 18432
    v_lshl_add_u32 v244, v252, 4, s58
    s_and_b32 s58, s3, 3
    s_mul_i32 s59, s58, 4608
    s_lshr_b32 s60, s3, 2
    s_xor_b32 s60, s60, 1
    s_lshl_b32 s61, s60, 11
    s_add_u32 s59, s59, s61
    v_lshl_add_u32 v245, v252, 4, s59
    v_add_u32 v250, 55296, v245
    v_add_u32 v251, 110592, v245
    v_cmp_gt_u32 vcc, 32, v252
    v_mov_b32 v253, 0x40000
    s_nop 0
    v_cndmask_b32 v253, v253, v244, vcc
    s_waitcnt vmcnt(0)
    v_mfma_f32_16x16x16_bf16 v[0:3], v[232:233], v[144:145], v[0:3]
    v_mfma_f32_16x16x16_bf16 v[4:7], v[234:235], v[144:145], v[4:7]
    v_mfma_f32_16x16x16_bf16 v[8:11], v[236:237], v[144:145], v[8:11]
    v_mfma_f32_16x16x16_bf16 v[12:15], v[238:239], v[144:145], v[12:15]
    v_mfma_f32_16x16x16_bf16 v[16:19], v[240:241], v[144:145], v[16:19]
    v_mfma_f32_16x16x16_bf16 v[20:23], v[232:233], v[146:147], v[20:23]
    v_mfma_f32_16x16x16_bf16 v[24:27], v[234:235], v[146:147], v[24:27]
    v_mfma_f32_16x16x16_bf16 v[28:31], v[236:237], v[146:147], v[28:31]
    v_mfma_f32_16x16x16_bf16 v[32:35], v[238:239], v[146:147], v[32:35]
    ds_write_b128 v244, v[0:3] offset:0
    v_mfma_f32_16x16x16_bf16 v[36:39], v[240:241], v[146:147], v[36:39]
    ds_write_b128 v244, v[4:7] offset:1024
    v_mfma_f32_16x16x16_bf16 v[40:43], v[232:233], v[148:149], v[40:43]
    ds_write_b128 v244, v[8:11] offset:2048
    v_mfma_f32_16x16x16_bf16 v[44:47], v[234:235], v[148:149], v[44:47]
    ds_write_b128 v244, v[12:15] offset:3072
    v_mfma_f32_16x16x16_bf16 v[48:51], v[236:237], v[148:149], v[48:51]
    ds_write_b128 v253, v[16:19] offset:4096
    v_mfma_f32_16x16x16_bf16 v[52:55], v[238:239], v[148:149], v[52:55]
    ds_write_b128 v244, v[20:23] offset:4608
    v_mfma_f32_16x16x16_bf16 v[56:59], v[240:241], v[148:149], v[56:59]
    ds_write_b128 v244, v[24:27] offset:5632
    v_mfma_f32_16x16x16_bf16 v[60:63], v[232:233], v[150:151], v[60:63]
    ds_write_b128 v244, v[28:31] offset:6656
    v_mfma_f32_16x16x16_bf16 v[64:67], v[234:235], v[150:151], v[64:67]
    ds_write_b128 v244, v[32:35] offset:7680
    v_mfma_f32_16x16x16_bf16 v[68:71], v[236:237], v[150:151], v[68:71]
    ds_write_b128 v253, v[36:39] offset:8704
    v_mfma_f32_16x16x16_bf16 v[72:75], v[238:239], v[150:151], v[72:75]
    ds_write_b128 v244, v[40:43] offset:9216
    v_mfma_f32_16x16x16_bf16 v[76:79], v[240:241], v[150:151], v[76:79]
    ds_write_b128 v244, v[44:47] offset:10240
    s_nop 3
    ds_write_b128 v244, v[48:51] offset:11264
    ds_write_b128 v244, v[52:55] offset:12288
    ds_write_b128 v253, v[56:59] offset:13312
    ds_write_b128 v244, v[60:63] offset:13824
    ds_write_b128 v244, v[64:67] offset:14848
    ds_write_b128 v244, v[68:71] offset:15872
    ds_write_b128 v244, v[72:75] offset:16896
    ds_write_b128 v253, v[76:79] offset:17920
    s_mov_b32 s20, s42
    s_mov_b32 s21, s43
    s_mov_b32 s22, 2359296
    s_mov_b32 s23, 0x00020000
    s_lshl_b32 s59, s50, 6
    s_lshl_b32 s58, s58, 4
    s_add_u32 s59, s59, s58
    v_add_u32 v84, s59, v246
    v_mul_u32_u24 v84, 1152, v84
    v_lshl_add_u32 v85, v247, 3, v84
    v_lshl_add_u32 v84, v247, 4, v84
    s_mul_i32 s59, s51, 144
    s_lshl_b32 s61, s60, 6
    s_add_u32 s61, s61, s59
    s_waitcnt lgkmcnt(0)
    s_barrier
    ds_read_b128 v[0:3], v245 offset:0
    ds_read_b128 v[4:7], v245 offset:18432
    ds_read_b128 v[8:11], v245 offset:36864
    ds_read_b128 v[12:15], v250 offset:0
    ds_read_b128 v[16:19], v250 offset:18432
    ds_read_b128 v[20:23], v250 offset:36864
    ds_read_b128 v[24:27], v251 offset:0
    ds_read_b128 v[28:31], v251 offset:18432
    ds_read_b128 v[32:35], v245 offset:1024
    ds_read_b128 v[36:39], v245 offset:19456
    ds_read_b128 v[40:43], v245 offset:37888
    ds_read_b128 v[44:47], v250 offset:1024
    ds_read_b128 v[48:51], v250 offset:19456
    ds_read_b128 v[52:55], v250 offset:37888
    ds_read_b128 v[56:59], v251 offset:1024
    ds_read_b128 v[60:63], v251 offset:19456
    s_waitcnt lgkmcnt(8)
    v_pk_add_f32 v[0:1], v[0:1], v[4:5]
    v_pk_add_f32 v[2:3], v[2:3], v[6:7]
    v_pk_add_f32 v[8:9], v[8:9], v[12:13]
    v_pk_add_f32 v[10:11], v[10:11], v[14:15]
    v_pk_add_f32 v[16:17], v[16:17], v[20:21]
    v_pk_add_f32 v[18:19], v[18:19], v[22:23]
    v_pk_add_f32 v[24:25], v[24:25], v[28:29]
    v_pk_add_f32 v[26:27], v[26:27], v[30:31]
    v_pk_add_f32 v[0:1], v[0:1], v[8:9]
    v_pk_add_f32 v[2:3], v[2:3], v[10:11]
    v_pk_add_f32 v[16:17], v[16:17], v[24:25]
    v_pk_add_f32 v[18:19], v[18:19], v[26:27]
    v_mul_f32 v0, v242, v0
    v_mul_f32 v1, v242, v1
    v_mul_f32 v2, v242, v2
    v_mul_f32 v3, v242, v3
    v_fmac_f32 v0, v243, v16
    v_fmac_f32 v1, v243, v17
    v_fmac_f32 v2, v243, v18
    v_fmac_f32 v3, v243, v19
    v_cvt_pk_bf16_f32 v88, v0, v1
    v_cvt_pk_bf16_f32 v89, v2, v3
    s_cmp_eq_u32 s60, 0
    s_cbranch_scc1 .Lout_half0
    ds_read_b128 v[96:99], v245 offset:2048
    ds_read_b128 v[100:103], v245 offset:20480
    ds_read_b128 v[104:107], v245 offset:38912
    ds_read_b128 v[108:111], v250 offset:2048
    ds_read_b128 v[112:115], v250 offset:20480
    ds_read_b128 v[116:119], v250 offset:38912
    ds_read_b128 v[120:123], v251 offset:2048
    ds_read_b128 v[124:127], v251 offset:20480
    s_waitcnt lgkmcnt(8)
    v_pk_add_f32 v[32:33], v[32:33], v[36:37]
    v_pk_add_f32 v[34:35], v[34:35], v[38:39]
    v_pk_add_f32 v[40:41], v[40:41], v[44:45]
    v_pk_add_f32 v[42:43], v[42:43], v[46:47]
    v_pk_add_f32 v[48:49], v[48:49], v[52:53]
    v_pk_add_f32 v[50:51], v[50:51], v[54:55]
    v_pk_add_f32 v[56:57], v[56:57], v[60:61]
    v_pk_add_f32 v[58:59], v[58:59], v[62:63]
    v_pk_add_f32 v[32:33], v[32:33], v[40:41]
    v_pk_add_f32 v[34:35], v[34:35], v[42:43]
    v_pk_add_f32 v[48:49], v[48:49], v[56:57]
    v_pk_add_f32 v[50:51], v[50:51], v[58:59]
    v_mul_f32 v32, v242, v32
    v_mul_f32 v33, v242, v33
    v_mul_f32 v34, v242, v34
    v_mul_f32 v35, v242, v35
    v_fmac_f32 v32, v243, v48
    v_fmac_f32 v33, v243, v49
    v_fmac_f32 v34, v243, v50
    v_fmac_f32 v35, v243, v51
    v_cvt_pk_bf16_f32 v90, v32, v33
    v_cvt_pk_bf16_f32 v91, v34, v35
    buffer_store_dwordx4 v[88:91], v84, s[20:23], s61 offen
    s_waitcnt lgkmcnt(0)
    v_pk_add_f32 v[96:97], v[96:97], v[100:101]
    v_pk_add_f32 v[98:99], v[98:99], v[102:103]
    v_pk_add_f32 v[104:105], v[104:105], v[108:109]
    v_pk_add_f32 v[106:107], v[106:107], v[110:111]
    v_pk_add_f32 v[112:113], v[112:113], v[116:117]
    v_pk_add_f32 v[114:115], v[114:115], v[118:119]
    v_pk_add_f32 v[120:121], v[120:121], v[124:125]
    v_pk_add_f32 v[122:123], v[122:123], v[126:127]
    v_pk_add_f32 v[96:97], v[96:97], v[104:105]
    v_pk_add_f32 v[98:99], v[98:99], v[106:107]
    v_pk_add_f32 v[112:113], v[112:113], v[120:121]
    v_pk_add_f32 v[114:115], v[114:115], v[122:123]
    v_mul_f32 v96, v242, v96
    v_mul_f32 v97, v242, v97
    v_mul_f32 v98, v242, v98
    v_mul_f32 v99, v242, v99
    v_fmac_f32 v96, v243, v112
    v_fmac_f32 v97, v243, v113
    v_fmac_f32 v98, v243, v114
    v_fmac_f32 v99, v243, v115
    v_cvt_pk_bf16_f32 v92, v96, v97
    v_cvt_pk_bf16_f32 v93, v98, v99
    s_mov_b32 exec_hi, 0
    buffer_store_dwordx2 v[92:93], v85, s[20:23], s59 offen offset:128
    s_mov_b32 exec_hi, -1
    s_branch .Lout_fin
.Lout_half0:
    s_waitcnt lgkmcnt(0)
    v_pk_add_f32 v[32:33], v[32:33], v[36:37]
    v_pk_add_f32 v[34:35], v[34:35], v[38:39]
    v_pk_add_f32 v[40:41], v[40:41], v[44:45]
    v_pk_add_f32 v[42:43], v[42:43], v[46:47]
    v_pk_add_f32 v[48:49], v[48:49], v[52:53]
    v_pk_add_f32 v[50:51], v[50:51], v[54:55]
    v_pk_add_f32 v[56:57], v[56:57], v[60:61]
    v_pk_add_f32 v[58:59], v[58:59], v[62:63]
    v_pk_add_f32 v[32:33], v[32:33], v[40:41]
    v_pk_add_f32 v[34:35], v[34:35], v[42:43]
    v_pk_add_f32 v[48:49], v[48:49], v[56:57]
    v_pk_add_f32 v[50:51], v[50:51], v[58:59]
    v_mul_f32 v32, v242, v32
    v_mul_f32 v33, v242, v33
    v_mul_f32 v34, v242, v34
    v_mul_f32 v35, v242, v35
    v_fmac_f32 v32, v243, v48
    v_fmac_f32 v33, v243, v49
    v_fmac_f32 v34, v243, v50
    v_fmac_f32 v35, v243, v51
    v_cvt_pk_bf16_f32 v90, v32, v33
    v_cvt_pk_bf16_f32 v91, v34, v35
    buffer_store_dwordx4 v[88:91], v84, s[20:23], s61 offen
.Lout_fin:
.Lend:
    s_endpgm
.Lattn_fallback:
    s_waitcnt vmcnt(0)
    s_mov_b32 s55, 1
    v_lshlrev_b32 v119, 4, v252
    v_mov_b32 v120, v121
    v_mov_b32 v140, v144
    v_mov_b32 v141, v145
    v_mov_b32 v142, v146
    v_mov_b32 v143, v147
    v_mov_b32 v64, 0xff800000
    v_mov_b32 v65, 0xff800000
    v_mov_b32 v105, 0
    v_mov_b32 v107, 0
    s_mov_b32 s54, 32
.Lattn_maxloop:
    ds_read_b128 v[108:111], v119
    ds_read_b128 v[112:115], v119 offset:1024
    ds_read_b32 v116, v120
    s_waitcnt lgkmcnt(0)
    v_mfma_f32_32x32x16_bf16 v[0:15], v[108:111], v[96:99], 0
    v_mfma_f32_32x32x16_bf16 v[16:31], v[112:115], v[96:99], 0
    v_mfma_f32_32x32x16_bf16 v[32:47], v[108:111], v[100:103], 0
    v_mfma_f32_32x32x16_bf16 v[48:63], v[112:115], v[100:103], 0
    s_nop 10
    v_mfma_f32_32x32x4_2b_bf16 v[0:31], v[116:117], v[104:105], v[0:31]
    v_mfma_f32_32x32x4_2b_bf16 v[32:63], v[116:117], v[106:107], v[32:63]
    s_nop 15
    s_nop 4
    v_max3_f32 v64, v0, v1, v64
    v_max3_f32 v64, v2, v3, v64
    v_max3_f32 v64, v4, v5, v64
    v_max3_f32 v64, v6, v7, v64
    v_max3_f32 v64, v8, v9, v64
    v_max3_f32 v64, v10, v11, v64
    v_max3_f32 v64, v12, v13, v64
    v_max3_f32 v64, v14, v15, v64
    v_max3_f32 v64, v16, v17, v64
    v_max3_f32 v64, v18, v19, v64
    v_max3_f32 v64, v20, v21, v64
    v_max3_f32 v64, v22, v23, v64
    v_max3_f32 v64, v24, v25, v64
    v_max3_f32 v64, v26, v27, v64
    v_max3_f32 v64, v28, v29, v64
    v_max3_f32 v64, v30, v31, v64
    v_max3_f32 v65, v32, v33, v65
    v_max3_f32 v65, v34, v35, v65
    v_max3_f32 v65, v36, v37, v65
    v_max3_f32 v65, v38, v39, v65
    v_max3_f32 v65, v40, v41, v65
    v_max3_f32 v65, v42, v43, v65
    v_max3_f32 v65, v44, v45, v65
    v_max3_f32 v65, v46, v47, v65
    v_max3_f32 v65, v48, v49, v65
    v_max3_f32 v65, v50, v51, v65
    v_max3_f32 v65, v52, v53, v65
    v_max3_f32 v65, v54, v55, v65
    v_max3_f32 v65, v56, v57, v65
    v_max3_f32 v65, v58, v59, v65
    v_max3_f32 v65, v60, v61, v65
    v_max3_f32 v65, v62, v63, v65
    v_add_u32 v119, 4864, v119
    v_add_u32 v120, 4864, v120
    s_sub_u32 s54, s54, 1
    s_cmp_lg_u32 s54, 0
    s_cbranch_scc1 .Lattn_maxloop
    v_mov_b32 v66, v64
    v_mov_b32 v67, v65
    s_nop 1
    v_permlane32_swap_b32 v64, v66
    v_permlane32_swap_b32 v65, v67
    s_nop 1
    v_max_f32 v64, v64, v66
    v_max_f32 v65, v65, v67
    v_cvt_pk_bf16_f32 v66, v64, v64
    v_cvt_pk_bf16_f32 v67, v65, v65
    v_lshlrev_b32 v66, 16, v66
    v_lshlrev_b32 v67, 16, v67
    v_sub_f32 v64, v64, v66
    v_sub_f32 v65, v65, v67
    v_cvt_pk_bf16_f32 v105, -v66, -v64
    v_cvt_pk_bf16_f32 v107, -v67, -v65
    v_lshlrev_b32 v119, 4, v252
    v_mov_b32 v120, v121
    v_mov_b32 v140, v144
    v_mov_b32 v141, v145
    v_mov_b32 v142, v146
    v_mov_b32 v143, v147
    ds_read_b128 v[108:111], v119
    ds_read_b128 v[112:115], v119 offset:1024
    ds_read_b32 v116, v120
    ds_read_b64_tr_b16 v[124:125], v140 offset:0
    ds_read_b64_tr_b16 v[126:127], v140 offset:128
    ds_read_b64_tr_b16 v[128:129], v141 offset:0
    ds_read_b64_tr_b16 v[130:131], v141 offset:128
    ds_read_b64_tr_b16 v[132:133], v142 offset:0
    ds_read_b64_tr_b16 v[134:135], v142 offset:128
    v_mov_b32 v64, 0
    v_mov_b32 v65, 0
    v_mov_b32 v66, 0
    v_mov_b32 v67, 0
    v_mov_b32 v68, 0
    v_mov_b32 v69, 0
    v_mov_b32 v70, 0
    v_mov_b32 v71, 0
    v_mov_b32 v72, 0
    v_mov_b32 v73, 0
    v_mov_b32 v74, 0
    v_mov_b32 v75, 0
    v_mov_b32 v76, 0
    v_mov_b32 v77, 0
    v_mov_b32 v78, 0
    v_mov_b32 v79, 0
    v_mov_b32 v80, 0
    v_mov_b32 v81, 0
    v_mov_b32 v82, 0
    v_mov_b32 v83, 0
    v_mov_b32 v84, 0
    v_mov_b32 v85, 0
    v_mov_b32 v86, 0
    v_mov_b32 v87, 0
    v_mov_b32 v88, 0
    v_mov_b32 v89, 0
    v_mov_b32 v90, 0
    v_mov_b32 v91, 0
    v_mov_b32 v92, 0
    v_mov_b32 v93, 0
    v_mov_b32 v94, 0
    v_mov_b32 v95, 0
    v_mov_b32 v56, 0
    v_mov_b32 v57, 0
    v_mov_b32 v58, 0
    v_mov_b32 v59, 0
    v_mov_b32 v60, 0
    v_mov_b32 v61, 0
    v_mov_b32 v62, 0
    v_mov_b32 v63, 0
    s_waitcnt lgkmcnt(0)
    v_mfma_f32_32x32x16_bf16 v[0:15], v[108:111], v[96:99], 0
    v_mfma_f32_32x32x16_bf16 v[16:31], v[112:115], v[96:99], 0
    s_nop 10
    v_mfma_f32_32x32x4_2b_bf16 v[0:31], v[116:117], v[104:105], v[0:31]
    s_nop 15
    s_nop 4
    s_mov_b32 s54, 4
    s_branch .Lattn_loop
.section .rodata,"a"
.p2align 6
.amdhsa_kernel gated_mix__softmax_full_mha__softmax_full_mha__prompt_kernel
  .amdhsa_next_free_vgpr 256
  .amdhsa_next_free_sgpr 100
  .amdhsa_accum_offset 256
  .amdhsa_group_segment_fixed_size 0
  .amdhsa_kernarg_size 80
  .amdhsa_user_sgpr_count 2
  .amdhsa_user_sgpr_kernarg_segment_ptr 1
  .amdhsa_system_sgpr_workgroup_id_x 1
.end_amdhsa_kernel
```
